```python
import torch

def _softmax(x, axis=-1):
    return torch.softmax(x, dim=axis)
def _gelu(x):
    return torch.nn.functional.gelu(x, approximate="tanh")
def _silu(x):
    return torch.nn.functional.silu(x)
def _sigmoid(x):
    return torch.sigmoid(x)
def _layernorm(x, axis=-1, eps=1e-5):
    m = x.mean(dim=axis, keepdim=True)
    v = x.var(dim=axis, keepdim=True, unbiased=False)
    return (x - m) / torch.sqrt(v + eps)
def _scatter_add(tgt, idx, src, axis=0):
    return tgt.clone().index_add_(axis, idx, src)
def _segment_sum(src, seg, n):
    out = torch.zeros((n,) + src.shape[1:], dtype=src.dtype)
    return out.index_add_(0, seg, src)
def _pad(x, pw):
    flat = tuple(v for pair in reversed(pw) for v in pair)
    return torch.nn.functional.pad(x, flat)

kernel_name = 'standalone__weight_only_int_quip__sampling'

def setup_inputs():

    _w = (lambda a: (lambda t: t.to(torch.bfloat16) if t.is_floating_point() else t)(torch.as_tensor(a)))
    B, S, D, F = 32, 8, 1024, 3584
    G = 64 if 64 > 0 else D
    D = (D // G) * G
    ng = D // G
    bits = 4 if 4 > 0 else 4
    qmax = 1 << bits
    qw = torch.randint(0, qmax, (D, F)).to(torch.int32)
    U, _ = (lambda *_a, **_k: torch.linalg.qr(*[torch.as_tensor(_x).float() for _x in _a], **_k))((lambda *s: torch.randn(*s, dtype=torch.bfloat16) * 0.05)(D, D))
    V, _ = (lambda *_a, **_k: torch.linalg.qr(*[torch.as_tensor(_x).float() for _x in _a], **_k))((lambda *s: torch.randn(*s, dtype=torch.bfloat16) * 0.05)(F, F))
    return {
        "x": _w((lambda *s: torch.randn(*s, dtype=torch.bfloat16) * 0.05)(B, S, D)),
        "qw": _w(qw),
        "scales": _w(torch.abs((lambda *s: torch.randn(*s, dtype=torch.bfloat16) * 0.05)(ng, F)) * 0.02 + 0.005),
        "zeros": _w(torch.full((ng, F), qmax / 2.0, dtype=float)),
        "U": _w(U.to(float)),
        "V": _w(V.to(float)),
    }

def reference(x, qw, scales, zeros, U, V):
    B, S, D = x.shape
    ng, F = scales.shape
    G = D // ng
    s = (lambda x, n, axis: torch.repeat_interleave(x, n, dim=axis))(scales, G, axis=0)
    z = (lambda x, n, axis: torch.repeat_interleave(x, n, dim=axis))(zeros, G, axis=0)
    wq = ((lambda x, dt: x.to(dt))(qw, x.dtype) - z) * s
    xr = torch.einsum("bsd,de->bse", x, U)
    h  = torch.einsum("bse,ef->bsf", xr, wq)
    y  = torch.einsum("bsf,fg->bsg", h, V)
    return y
```

```asm
; @launch grid=(256,1,1) block=(256,1,1) lds=163840
.amdgcn_target "amdgcn-amd-amdhsa--gfx950"
.text
.globl standalone__weight_only_int_quip__sampling_kernel
.p2align 8
.type standalone__weight_only_int_quip__sampling_kernel,@function
standalone__weight_only_int_quip__sampling_kernel:
    s_cmp_ge_u32 s2, 256
    s_cbranch_scc1 DONE
    s_load_dwordx16 s[8:23], s[0:1], 0
    s_load_dwordx2 s[24:25], s[0:1], 64
    s_cmp_lt_u32 s2, 240
    s_cbranch_scc1 NOCW
    s_getpc_b64 s[72:73]
PCREF:
    s_sub_u32 s72, s72, PCREF-standalone__weight_only_int_quip__sampling_kernel
    s_subb_u32 s73, s73, 0
    v_lshlrev_b32 v240, 7, v0
    v_add_u32 v242, 0x8000, v240
    v_min_u32 v242, DONE-standalone__weight_only_int_quip__sampling_kernel, v242
    v_min_u32 v240, DONE-standalone__weight_only_int_quip__sampling_kernel, v240
    v_mov_b32 v241, s73
    v_mov_b32 v243, s73
    v_add_co_u32 v240, vcc, s72, v240
    v_addc_co_u32 v241, vcc, 0, v241, vcc
    v_add_co_u32 v242, vcc, s72, v242
    v_addc_co_u32 v243, vcc, 0, v243, vcc
    global_load_dword v244, v[240:241], off
    global_load_dword v245, v[242:243], off
NOCW:
    v_lshrrev_b32 v4, 6, v0
    v_and_b32 v1, 63, v0
    v_readfirstlane_b32 s4, v4
    v_lshrrev_b32 v2, 4, v1
    v_and_b32 v3, 15, v1
    v_lshlrev_b32 v4, 4, v1
    v_mov_b32 v0, 0
    s_and_b32 s60, s2, 7
    s_lshr_b32 s70, s2, 3
    s_and_b32 s61, s70, 1
    s_lshr_b32 s62, s70, 1
    s_mul_i32 s74, s4, 40960
    s_bitcmp1_b32 s62, 0
    s_cbranch_scc1 ROLE_B
ROLE_A:
    s_lshr_b32 s70, s62, 1
    s_and_b32 s71, s70, 1
    s_lshl_b32 s64, s60, 1
    s_add_u32 s64, s64, s71
    s_lshr_b32 s70, s70, 1
    s_lshl_b32 s63, s61, 2
    s_add_u32 s63, s63, s70
    s_lshl_b32 s71, s71, 1
    s_add_u32 s89, s63, s71
    s_lshl_b32 s70, s64, 7
    s_lshl_b32 s71, s4, 19
    s_add_u32 s70, s70, s71
    v_lshrrev_b32 v224, 3, v1
    v_and_b32 v225, 2, v224
    v_mul_u32_u24 v224, 2048, v224
    v_and_b32 v7, 7, v1
    v_xor_b32 v225, v225, v7
    v_lshl_add_u32 v224, v225, 4, v224
    v_add_u32 v224, s70, v224
    v_xor_b32 v225, 64, v224
    v_lshrrev_b32 v5, 3, v1
    v_lshlrev_b32 v5, 11, v5
    v_xor_b32 v7, v7, v2
    v_lshl_add_u32 v5, v7, 4, v5
    s_lshl_b32 s70, s63, 16
    s_lshl_b32 s71, s4, 9
    s_add_u32 s70, s70, s71
    v_add_u32 v5, s70, v5
    v_xor_b32 v6, 64, v5
    s_waitcnt lgkmcnt(0)
    s_mov_b32 s44, s16
    s_and_b32 s45, s17, 0xffff
    s_mov_b32 s46, 0x200000
    s_mov_b32 s47, 0x20000
    s_mov_b32 s28, s8
    s_and_b32 s29, s9, 0xffff
    s_mov_b32 s30, 0x80000
    s_mov_b32 s31, 0x20000
    s_lshl_b32 s87, s61, 16
    s_add_u32 s77, s89, 0
    s_and_b32 s77, s77, 3
    s_lshl_b32 s76, s77, 7
    s_add_u32 m0, s74, 32768
    s_nop 0
    buffer_load_dwordx4 v5, s[28:31], s76 offen lds
    s_add_u32 m0, s74, 33792
    s_add_u32 s76, s76, 0x4000
    buffer_load_dwordx4 v6, s[28:31], s76 offen lds
    s_add_u32 m0, s74, 34816
    s_add_u32 s76, s76, 0x4000
    buffer_load_dwordx4 v5, s[28:31], s76 offen lds
    s_add_u32 m0, s74, 35840
    s_add_u32 s76, s76, 0x4000
    buffer_load_dwordx4 v6, s[28:31], s76 offen lds
    s_add_u32 s77, s89, 1
    s_and_b32 s77, s77, 3
    s_lshl_b32 s76, s77, 7
    s_add_u32 m0, s74, 36864
    s_nop 0
    buffer_load_dwordx4 v5, s[28:31], s76 offen lds
    s_add_u32 m0, s74, 37888
    s_add_u32 s76, s76, 0x4000
    buffer_load_dwordx4 v6, s[28:31], s76 offen lds
    s_add_u32 m0, s74, 38912
    s_add_u32 s76, s76, 0x4000
    buffer_load_dwordx4 v5, s[28:31], s76 offen lds
    s_add_u32 m0, s74, 39936
    s_add_u32 s76, s76, 0x4000
    buffer_load_dwordx4 v6, s[28:31], s76 offen lds
    s_add_u32 s77, s89, 0
    s_and_b32 s77, s77, 3
    s_lshl_b32 s76, s77, 17
    s_xor_b32 s76, s76, s87
    s_add_u32 m0, s74, 0
    s_nop 0
    buffer_load_dwordx4 v224, s[44:47], s76 offen lds
    s_add_u32 m0, s74, 1024
    s_add_u32 s76, s76, 0x4000
    buffer_load_dwordx4 v225, s[44:47], s76 offen lds
    s_add_u32 m0, s74, 2048
    s_add_u32 s76, s76, 0x4000
    buffer_load_dwordx4 v224, s[44:47], s76 offen lds
    s_add_u32 m0, s74, 3072
    s_add_u32 s76, s76, 0x4000
    buffer_load_dwordx4 v225, s[44:47], s76 offen lds
    s_lshl_b32 s70, s61, 7
    s_add_u32 s70, s70, 0x308000
    s_load_dword s5, s[24:25], s70
    s_mov_b32 s48, s18
    s_and_b32 s49, s19, 0xffff
    s_mov_b32 s50, 0x1880000
    s_mov_b32 s51, 0x20000
    s_mov_b32 s52, s20
    s_and_b32 s53, s21, 0xffff
    s_mov_b32 s54, 0x1c0000
    s_mov_b32 s55, 0x20000
    s_mov_b32 s56, s24
    s_and_b32 s57, s25, 0xffff
    s_mov_b32 s58, 0x800000
    s_mov_b32 s59, 0x20000
    v_lshrrev_b32 v12, 2, v3
    v_lshrrev_b32 v13, 1, v12
    v_and_b32 v14, 1, v2
    v_lshl_add_u32 v13, v14, 1, v13
    v_lshl_add_u32 v12, v2, 3, v12
    v_lshlrev_b32 v12, 7, v12
    v_lshl_add_u32 v12, v13, 5, v12
    v_and_b32 v13, 3, v1
    v_lshl_add_u32 v12, v13, 3, v12
    v_add_u32 v12, s74, v12
    v_xor_b32 v13, 32, v12
    v_xor_b32 v14, 64, v12
    v_xor_b32 v15, 96, v12
    v_lshrrev_b32 v226, 1, v3
    v_xor_b32 v226, v226, v2
    v_lshlrev_b32 v226, 4, v226
    v_lshl_add_u32 v226, v3, 7, v226
    v_add_u32 v226, s74, v226
    s_lshl_b32 s70, s61, 6
    v_xor_b32 v226, s70, v226
    v_xor_b32 v227, 64, v226
    v_add_u32 v232, s74, v4
    s_lshl_b32 s70, s4, 11
    s_add_u32 s70, s70, 32768
    v_add_u32 v233, s70, v4
    v_add_u32 v234, 0x14000, v233
    s_and_b32 s71, s4, 1
    s_lshl_b32 s70, s63, 1
    s_add_u32 s70, s70, s71
    s_lshr_b32 s71, s4, 1
    s_lshl_b32 s72, s64, 1
    s_add_u32 s72, s72, s71
    s_lshl_b32 s97, s70, 5
    s_add_u32 s97, s97, s72
    s_lshl_b32 s97, s97, 10
    s_lshl_b32 s71, s61, 4
    s_add_u32 s71, s71, s64
    s_lshl_b32 s71, s71, 2
    s_and_b32 s70, s63, 3
    s_add_u32 s71, s71, s70
    s_lshl_b32 s71, s71, 7
    s_add_u32 s86, s71, 0x300000
    s_and_b32 s67, s60, 1
    s_lshr_b32 s70, s60, 1
    s_mul_i32 s68, s70, 14
    s_xor_b32 s70, s62, s67
    s_add_u32 s68, s68, s70
    s_lshl_b32 s70, s68, 7
    v_lshrrev_b32 v10, 3, v1
    v_and_b32 v11, 2, v10
    v_mul_u32_u24 v10, 7168, v10
    v_and_b32 v7, 7, v1
    v_xor_b32 v11, v11, v7
    v_lshl_add_u32 v10, v11, 4, v10
    v_add_u32 v10, s70, v10
    v_xor_b32 v11, 64, v10
    s_mul_i32 s70, s67, 48
    s_mul_i32 s71, s4, 16
    s_add_u32 s70, s70, s71
    s_mul_i32 s90, s70, 229376
    v_min_u32 v237, 7, v1
    v_lshlrev_b32 v237, 7, v237
    s_lshr_b32 s70, s70, 1
    s_mul_i32 s71, s61, 56
    s_add_u32 s71, s70, s71
    s_lshl_b32 s71, s71, 7
    s_add_u32 s7, s71, 0x304000
    s_add_u32 s6, s7, 32768
    s_mul_i32 s70, s67, 64
    s_mul_i32 s71, s4, 12
    s_add_u32 s70, s70, s71
    s_mul_i32 s78, s70, 229376
    s_lshl_b32 s70, s67, 8
    s_add_u32 s78, s78, 128
    s_sub_u32 s78, s78, s70
    s_and_b32 s70, s68, 7
    s_cmp_eq_u32 s70, 3
    s_cselect_b32 s70, 0x7f000000, 0
    v_add_u32 v236, s70, v10
    s_add_u32 s77, s89, 0
    s_and_b32 s77, s77, 3
    s_lshl_b32 s76, s77, 17
    s_add_u32 s76, s76, 0x10000
    s_xor_b32 s76, s76, s87
    s_add_u32 m0, s74, 4096
    s_nop 0
    buffer_load_dwordx4 v224, s[44:47], s76 offen lds
    s_add_u32 m0, s74, 5120
    s_add_u32 s76, s76, 0x4000
    buffer_load_dwordx4 v225, s[44:47], s76 offen lds
    s_add_u32 m0, s74, 6144
    s_add_u32 s76, s76, 0x4000
    buffer_load_dwordx4 v224, s[44:47], s76 offen lds
    s_add_u32 m0, s74, 7168
    s_add_u32 s76, s76, 0x4000
    buffer_load_dwordx4 v225, s[44:47], s76 offen lds
    s_waitcnt vmcnt(8)
    ds_read_b128 a[0:3], v226 offset:32768
    ds_read_b128 a[4:7], v226 offset:34816
    ds_read_b128 a[8:11], v227 offset:32768
    ds_read_b128 a[12:15], v227 offset:34816
    ds_read_b128 a[16:19], v226 offset:36864
    ds_read_b128 a[20:23], v226 offset:38912
    ds_read_b128 a[24:27], v227 offset:36864
    ds_read_b128 a[28:31], v227 offset:38912
    s_waitcnt lgkmcnt(0)
    s_mul_i32 s69, s5, 0x9e3779b1
    s_add_u32 s69, s69, 0x7f4a7c15
    s_lshr_b32 s70, s69, 15
    s_xor_b32 s69, s69, s70
    s_mul_i32 s69, s69, 0x85ebca6b
    s_add_u32 s77, s89, 2
    s_and_b32 s77, s77, 3
    s_lshl_b32 s76, s77, 7
    s_add_u32 m0, s74, 32768
    s_nop 0
    buffer_load_dwordx4 v5, s[28:31], s76 offen lds
    s_add_u32 m0, s74, 33792
    s_add_u32 s76, s76, 0x4000
    buffer_load_dwordx4 v6, s[28:31], s76 offen lds
    s_add_u32 m0, s74, 34816
    s_add_u32 s76, s76, 0x4000
    buffer_load_dwordx4 v5, s[28:31], s76 offen lds
    s_add_u32 m0, s74, 35840
    s_add_u32 s76, s76, 0x4000
    buffer_load_dwordx4 v6, s[28:31], s76 offen lds
    s_add_u32 s77, s89, 3
    s_and_b32 s77, s77, 3
    s_lshl_b32 s76, s77, 7
    s_add_u32 m0, s74, 36864
    s_nop 0
    buffer_load_dwordx4 v5, s[28:31], s76 offen lds
    s_add_u32 m0, s74, 37888
    s_add_u32 s76, s76, 0x4000
    buffer_load_dwordx4 v6, s[28:31], s76 offen lds
    s_add_u32 m0, s74, 38912
    s_add_u32 s76, s76, 0x4000
    buffer_load_dwordx4 v5, s[28:31], s76 offen lds
    s_add_u32 m0, s74, 39936
    s_add_u32 s76, s76, 0x4000
    buffer_load_dwordx4 v6, s[28:31], s76 offen lds
    s_add_u32 s77, s89, 1
    s_and_b32 s77, s77, 3
    s_lshl_b32 s76, s77, 17
    s_xor_b32 s76, s76, s87
    s_add_u32 m0, s74, 8192
    s_nop 0
    buffer_load_dwordx4 v224, s[44:47], s76 offen lds
    s_add_u32 m0, s74, 9216
    s_add_u32 s76, s76, 0x4000
    buffer_load_dwordx4 v225, s[44:47], s76 offen lds
    s_waitcnt vmcnt(14)
    ds_read_b64_tr_b16 a[64:65], v12 offset:0
    ds_read_b64_tr_b16 a[66:67], v12 offset:512
    ds_read_b64_tr_b16 a[68:69], v13 offset:0
    ds_read_b64_tr_b16 a[70:71], v13 offset:512
    ds_read_b64_tr_b16 a[72:73], v14 offset:0
    ds_read_b64_tr_b16 a[74:75], v14 offset:512
    ds_read_b64_tr_b16 a[76:77], v15 offset:0
    ds_read_b64_tr_b16 a[78:79], v15 offset:512
    s_waitcnt vmcnt(10)
    s_waitcnt lgkmcnt(0)
    ds_read_b64_tr_b16 a[80:81], v12 offset:4096
    ds_read_b64_tr_b16 a[82:83], v12 offset:4608
    ds_read_b64_tr_b16 a[84:85], v13 offset:4096
    ds_read_b64_tr_b16 a[86:87], v13 offset:4608
    ds_read_b64_tr_b16 a[88:89], v14 offset:4096
    ds_read_b64_tr_b16 a[90:91], v14 offset:4608
    ds_read_b64_tr_b16 a[92:93], v15 offset:4096
    ds_read_b64_tr_b16 a[94:95], v15 offset:4608
    v_mfma_f32_16x16x32_bf16 a[224:227], a[64:67], a[0:3], 0
    v_mfma_f32_16x16x32_bf16 a[232:235], a[64:67], a[4:7], 0
    s_add_u32 m0, s74, 10240
    s_add_u32 s76, s76, 0x4000
    buffer_load_dwordx4 v224, s[44:47], s76 offen lds
    s_add_u32 m0, s74, 11264
    s_add_u32 s76, s76, 0x4000
    buffer_load_dwordx4 v225, s[44:47], s76 offen lds
    v_mfma_f32_16x16x32_bf16 a[228:231], a[68:71], a[0:3], 0
    v_mfma_f32_16x16x32_bf16 a[236:239], a[68:71], a[4:7], 0
    s_add_u32 s77, s89, 1
    s_and_b32 s77, s77, 3
    s_lshl_b32 s76, s77, 17
    s_add_u32 s76, s76, 0x10000
    s_xor_b32 s76, s76, s87
    s_add_u32 m0, s74, 12288
    s_nop 0
    buffer_load_dwordx4 v224, s[44:47], s76 offen lds
    s_add_u32 m0, s74, 13312
    s_add_u32 s76, s76, 0x4000
    buffer_load_dwordx4 v225, s[44:47], s76 offen lds
    v_mfma_f32_16x16x32_bf16 a[240:243], a[72:75], a[0:3], 0
    v_mfma_f32_16x16x32_bf16 a[248:251], a[72:75], a[4:7], 0
    s_add_u32 m0, s74, 14336
    s_add_u32 s76, s76, 0x4000
    buffer_load_dwordx4 v224, s[44:47], s76 offen lds
    s_add_u32 m0, s74, 15360
    s_add_u32 s76, s76, 0x4000
    buffer_load_dwordx4 v225, s[44:47], s76 offen lds
    v_mfma_f32_16x16x32_bf16 a[244:247], a[76:79], a[0:3], 0
    v_mfma_f32_16x16x32_bf16 a[252:255], a[76:79], a[4:7], 0
    s_add_u32 s77, s89, 2
    s_and_b32 s77, s77, 3
    s_lshl_b32 s76, s77, 17
    s_xor_b32 s76, s76, s87
    s_add_u32 m0, s74, 16384
    s_nop 0
    buffer_load_dwordx4 v224, s[44:47], s76 offen lds
    s_add_u32 m0, s74, 17408
    s_add_u32 s76, s76, 0x4000
    buffer_load_dwordx4 v225, s[44:47], s76 offen lds
    s_waitcnt vmcnt(6)
    s_waitcnt lgkmcnt(0)
    ds_read_b64_tr_b16 a[64:65], v12 offset:8192
    ds_read_b64_tr_b16 a[66:67], v12 offset:8704
    ds_read_b64_tr_b16 a[68:69], v13 offset:8192
    ds_read_b64_tr_b16 a[70:71], v13 offset:8704
    ds_read_b64_tr_b16 a[72:73], v14 offset:8192
    ds_read_b64_tr_b16 a[74:75], v14 offset:8704
    ds_read_b64_tr_b16 a[76:77], v15 offset:8192
    ds_read_b64_tr_b16 a[78:79], v15 offset:8704
    v_mfma_f32_16x16x32_bf16 a[224:227], a[80:83], a[8:11], a[224:227]
    v_mfma_f32_16x16x32_bf16 a[232:235], a[80:83], a[12:15], a[232:235]
    s_add_u32 m0, s74, 18432
    s_add_u32 s76, s76, 0x4000
    buffer_load_dwordx4 v224, s[44:47], s76 offen lds
    s_add_u32 m0, s74, 19456
    s_add_u32 s76, s76, 0x4000
    buffer_load_dwordx4 v225, s[44:47], s76 offen lds
    v_mfma_f32_16x16x32_bf16 a[228:231], a[84:87], a[8:11], a[228:231]
    v_mfma_f32_16x16x32_bf16 a[236:239], a[84:87], a[12:15], a[236:239]
    s_add_u32 s77, s89, 2
    s_and_b32 s77, s77, 3
    s_lshl_b32 s76, s77, 17
    s_add_u32 s76, s76, 0x10000
    s_xor_b32 s76, s76, s87
    s_add_u32 m0, s74, 20480
    s_nop 0
    buffer_load_dwordx4 v224, s[44:47], s76 offen lds
    s_add_u32 m0, s74, 21504
    s_add_u32 s76, s76, 0x4000
    buffer_load_dwordx4 v225, s[44:47], s76 offen lds
    v_mfma_f32_16x16x32_bf16 a[240:243], a[88:91], a[8:11], a[240:243]
    v_mfma_f32_16x16x32_bf16 a[248:251], a[88:91], a[12:15], a[248:251]
    s_add_u32 m0, s74, 22528
    s_add_u32 s76, s76, 0x4000
    buffer_load_dwordx4 v224, s[44:47], s76 offen lds
    s_add_u32 m0, s74, 23552
    s_add_u32 s76, s76, 0x4000
    buffer_load_dwordx4 v225, s[44:47], s76 offen lds
    v_mfma_f32_16x16x32_bf16 a[244:247], a[92:95], a[8:11], a[244:247]
    v_mfma_f32_16x16x32_bf16 a[252:255], a[92:95], a[12:15], a[252:255]
    s_add_u32 s77, s89, 3
    s_and_b32 s77, s77, 3
    s_lshl_b32 s76, s77, 17
    s_xor_b32 s76, s76, s87
    s_add_u32 m0, s74, 24576
    s_nop 0
    buffer_load_dwordx4 v224, s[44:47], s76 offen lds
    s_add_u32 m0, s74, 25600
    s_add_u32 s76, s76, 0x4000
    buffer_load_dwordx4 v225, s[44:47], s76 offen lds
    ds_read_b128 a[32:35], v226 offset:32768
    ds_read_b128 a[36:39], v226 offset:34816
    ds_read_b128 a[40:43], v227 offset:32768
    ds_read_b128 a[44:47], v227 offset:34816
    ds_read_b128 a[48:51], v226 offset:36864
    ds_read_b128 a[52:55], v226 offset:38912
    ds_read_b128 a[56:59], v227 offset:36864
    ds_read_b128 a[60:63], v227 offset:38912
    s_waitcnt vmcnt(10)
    s_waitcnt lgkmcnt(0)
    ds_read_b64_tr_b16 a[80:81], v12 offset:12288
    ds_read_b64_tr_b16 a[82:83], v12 offset:12800
    ds_read_b64_tr_b16 a[84:85], v13 offset:12288
    ds_read_b64_tr_b16 a[86:87], v13 offset:12800
    ds_read_b64_tr_b16 a[88:89], v14 offset:12288
    ds_read_b64_tr_b16 a[90:91], v14 offset:12800
    ds_read_b64_tr_b16 a[92:93], v15 offset:12288
    ds_read_b64_tr_b16 a[94:95], v15 offset:12800
    v_mfma_f32_16x16x32_bf16 a[224:227], a[64:67], a[16:19], a[224:227]
    v_mfma_f32_16x16x32_bf16 a[232:235], a[64:67], a[20:23], a[232:235]
    s_add_u32 m0, s74, 26624
    s_add_u32 s76, s76, 0x4000
    buffer_load_dwordx4 v224, s[44:47], s76 offen lds
    s_add_u32 m0, s74, 27648
    s_add_u32 s76, s76, 0x4000
    buffer_load_dwordx4 v225, s[44:47], s76 offen lds
    v_mfma_f32_16x16x32_bf16 a[228:231], a[68:71], a[16:19], a[228:231]
    v_mfma_f32_16x16x32_bf16 a[236:239], a[68:71], a[20:23], a[236:239]
    s_add_u32 s77, s89, 3
    s_and_b32 s77, s77, 3
    s_lshl_b32 s76, s77, 17
    s_add_u32 s76, s76, 0x10000
    s_xor_b32 s76, s76, s87
    s_add_u32 m0, s74, 28672
    s_nop 0
    buffer_load_dwordx4 v224, s[44:47], s76 offen lds
    s_add_u32 m0, s74, 29696
    s_add_u32 s76, s76, 0x4000
    buffer_load_dwordx4 v225, s[44:47], s76 offen lds
    v_mfma_f32_16x16x32_bf16 a[240:243], a[72:75], a[16:19], a[240:243]
    v_mfma_f32_16x16x32_bf16 a[248:251], a[72:75], a[20:23], a[248:251]
    s_add_u32 m0, s74, 30720
    s_add_u32 s76, s76, 0x4000
    buffer_load_dwordx4 v224, s[44:47], s76 offen lds
    s_add_u32 m0, s74, 31744
    s_add_u32 s76, s76, 0x4000
    buffer_load_dwordx4 v225, s[44:47], s76 offen lds
    v_mfma_f32_16x16x32_bf16 a[244:247], a[76:79], a[16:19], a[244:247]
    v_mfma_f32_16x16x32_bf16 a[252:255], a[76:79], a[20:23], a[252:255]
    s_waitcnt vmcnt(12)
    s_waitcnt lgkmcnt(0)
    ds_read_b64_tr_b16 a[64:65], v12 offset:16384
    ds_read_b64_tr_b16 a[66:67], v12 offset:16896
    ds_read_b64_tr_b16 a[68:69], v13 offset:16384
    ds_read_b64_tr_b16 a[70:71], v13 offset:16896
    ds_read_b64_tr_b16 a[72:73], v14 offset:16384
    ds_read_b64_tr_b16 a[74:75], v14 offset:16896
    ds_read_b64_tr_b16 a[76:77], v15 offset:16384
    ds_read_b64_tr_b16 a[78:79], v15 offset:16896
    v_mfma_f32_16x16x32_bf16 a[224:227], a[80:83], a[24:27], a[224:227]
    v_mfma_f32_16x16x32_bf16 a[232:235], a[80:83], a[28:31], a[232:235]
    v_mfma_f32_16x16x32_bf16 a[228:231], a[84:87], a[24:27], a[228:231]
    v_mfma_f32_16x16x32_bf16 a[236:239], a[84:87], a[28:31], a[236:239]
    v_mfma_f32_16x16x32_bf16 a[240:243], a[88:91], a[24:27], a[240:243]
    v_mfma_f32_16x16x32_bf16 a[248:251], a[88:91], a[28:31], a[248:251]
    v_mfma_f32_16x16x32_bf16 a[244:247], a[92:95], a[24:27], a[244:247]
    v_mfma_f32_16x16x32_bf16 a[252:255], a[92:95], a[28:31], a[252:255]
    s_waitcnt vmcnt(8)
    s_waitcnt lgkmcnt(0)
    ds_read_b64_tr_b16 a[80:81], v12 offset:20480
    ds_read_b64_tr_b16 a[82:83], v12 offset:20992
    ds_read_b64_tr_b16 a[84:85], v13 offset:20480
    ds_read_b64_tr_b16 a[86:87], v13 offset:20992
    ds_read_b64_tr_b16 a[88:89], v14 offset:20480
    ds_read_b64_tr_b16 a[90:91], v14 offset:20992
    ds_read_b64_tr_b16 a[92:93], v15 offset:20480
    ds_read_b64_tr_b16 a[94:95], v15 offset:20992
    v_mfma_f32_16x16x32_bf16 a[224:227], a[64:67], a[32:35], a[224:227]
    v_mfma_f32_16x16x32_bf16 a[232:235], a[64:67], a[36:39], a[232:235]
    v_mfma_f32_16x16x32_bf16 a[228:231], a[68:71], a[32:35], a[228:231]
    v_mfma_f32_16x16x32_bf16 a[236:239], a[68:71], a[36:39], a[236:239]
    v_mfma_f32_16x16x32_bf16 a[240:243], a[72:75], a[32:35], a[240:243]
    v_mfma_f32_16x16x32_bf16 a[248:251], a[72:75], a[36:39], a[248:251]
    v_mfma_f32_16x16x32_bf16 a[244:247], a[76:79], a[32:35], a[244:247]
    v_mfma_f32_16x16x32_bf16 a[252:255], a[76:79], a[36:39], a[252:255]
    s_waitcnt vmcnt(4)
    s_waitcnt lgkmcnt(0)
    ds_read_b64_tr_b16 a[64:65], v12 offset:24576
    ds_read_b64_tr_b16 a[66:67], v12 offset:25088
    ds_read_b64_tr_b16 a[68:69], v13 offset:24576
    ds_read_b64_tr_b16 a[70:71], v13 offset:25088
    ds_read_b64_tr_b16 a[72:73], v14 offset:24576
    ds_read_b64_tr_b16 a[74:75], v14 offset:25088
    ds_read_b64_tr_b16 a[76:77], v15 offset:24576
    ds_read_b64_tr_b16 a[78:79], v15 offset:25088
    v_mfma_f32_16x16x32_bf16 a[224:227], a[80:83], a[40:43], a[224:227]
    v_mfma_f32_16x16x32_bf16 a[232:235], a[80:83], a[44:47], a[232:235]
    v_mfma_f32_16x16x32_bf16 a[228:231], a[84:87], a[40:43], a[228:231]
    v_mfma_f32_16x16x32_bf16 a[236:239], a[84:87], a[44:47], a[236:239]
    v_mfma_f32_16x16x32_bf16 a[240:243], a[88:91], a[40:43], a[240:243]
    v_mfma_f32_16x16x32_bf16 a[248:251], a[88:91], a[44:47], a[248:251]
    v_mfma_f32_16x16x32_bf16 a[244:247], a[92:95], a[40:43], a[244:247]
    v_mfma_f32_16x16x32_bf16 a[252:255], a[92:95], a[44:47], a[252:255]
    s_waitcnt vmcnt(0)
    s_waitcnt lgkmcnt(0)
    ds_read_b64_tr_b16 a[80:81], v12 offset:28672
    ds_read_b64_tr_b16 a[82:83], v12 offset:29184
    ds_read_b64_tr_b16 a[84:85], v13 offset:28672
    ds_read_b64_tr_b16 a[86:87], v13 offset:29184
    ds_read_b64_tr_b16 a[88:89], v14 offset:28672
    ds_read_b64_tr_b16 a[90:91], v14 offset:29184
    ds_read_b64_tr_b16 a[92:93], v15 offset:28672
    ds_read_b64_tr_b16 a[94:95], v15 offset:29184
    v_mfma_f32_16x16x32_bf16 a[224:227], a[64:67], a[48:51], a[224:227]
    v_mfma_f32_16x16x32_bf16 a[232:235], a[64:67], a[52:55], a[232:235]
    v_mfma_f32_16x16x32_bf16 a[228:231], a[68:71], a[48:51], a[228:231]
    v_mfma_f32_16x16x32_bf16 a[236:239], a[68:71], a[52:55], a[236:239]
    v_mfma_f32_16x16x32_bf16 a[240:243], a[72:75], a[48:51], a[240:243]
    v_mfma_f32_16x16x32_bf16 a[248:251], a[72:75], a[52:55], a[248:251]
    v_mfma_f32_16x16x32_bf16 a[244:247], a[76:79], a[48:51], a[244:247]
    v_mfma_f32_16x16x32_bf16 a[252:255], a[76:79], a[52:55], a[252:255]
    s_waitcnt lgkmcnt(0)
    v_mfma_f32_16x16x32_bf16 a[224:227], a[80:83], a[56:59], a[224:227]
    v_mfma_f32_16x16x32_bf16 a[232:235], a[80:83], a[60:63], a[232:235]
    v_mfma_f32_16x16x32_bf16 a[228:231], a[84:87], a[56:59], a[228:231]
    v_mfma_f32_16x16x32_bf16 a[236:239], a[84:87], a[60:63], a[236:239]
    v_mfma_f32_16x16x32_bf16 a[240:243], a[88:91], a[56:59], a[240:243]
    v_mfma_f32_16x16x32_bf16 a[248:251], a[88:91], a[60:63], a[248:251]
    v_mfma_f32_16x16x32_bf16 a[244:247], a[92:95], a[56:59], a[244:247]
    v_mfma_f32_16x16x32_bf16 a[252:255], a[92:95], a[60:63], a[252:255]
    s_mov_b32 s70, 0x58000000
    v_mov_b32 v6, s70
    s_nop 3
    ds_write_b128 v232, a[224:227] offset:32768
    ds_write_b128 v232, a[232:235] offset:34816
    ds_write_b128 v232, a[228:231] offset:33792
    ds_write_b128 v232, a[236:239] offset:35840
    ds_write_b128 v232, a[240:243] offset:36864
    ds_write_b128 v232, a[248:251] offset:38912
    ds_write_b128 v232, a[244:247] offset:37888
    ds_write_b128 v232, a[252:255] offset:39936
    s_waitcnt lgkmcnt(0)
    s_barrier
    ds_read_b128 v[16:19], v233 offset:0
    ds_read_b128 v[20:23], v233 offset:1024
    ds_read_b128 v[24:27], v233 offset:40960
    ds_read_b128 v[28:31], v233 offset:41984
    ds_read_b128 v[32:35], v234 offset:0
    ds_read_b128 v[36:39], v234 offset:1024
    ds_read_b128 v[40:43], v234 offset:40960
    ds_read_b128 v[44:47], v234 offset:41984
    s_waitcnt lgkmcnt(4)
    v_pk_add_f32 v[16:17], v[16:17], v[24:25]
    v_pk_add_f32 v[18:19], v[18:19], v[26:27]
    v_pk_add_f32 v[20:21], v[20:21], v[28:29]
    v_pk_add_f32 v[22:23], v[22:23], v[30:31]
    s_waitcnt lgkmcnt(0)
    v_pk_add_f32 v[32:33], v[32:33], v[40:41]
    v_pk_add_f32 v[34:35], v[34:35], v[42:43]
    v_pk_add_f32 v[36:37], v[36:37], v[44:45]
    v_pk_add_f32 v[38:39], v[38:39], v[46:47]
    v_pk_add_f32 v[16:17], v[16:17], v[32:33]
    v_pk_add_f32 v[18:19], v[18:19], v[34:35]
    v_pk_add_f32 v[20:21], v[20:21], v[36:37]
    v_pk_add_f32 v[22:23], v[22:23], v[38:39]
    v_pk_mul_f32 v[16:17], v[16:17], v[6:7] op_sel_hi:[1,0]
    v_pk_mul_f32 v[18:19], v[18:19], v[6:7] op_sel_hi:[1,0]
    v_pk_mul_f32 v[20:21], v[20:21], v[6:7] op_sel_hi:[1,0]
    v_pk_mul_f32 v[22:23], v[22:23], v[6:7] op_sel_hi:[1,0]
    v_cvt_pk_bf16_f32 v48, v16, v17
    v_cvt_pk_bf16_f32 v49, v18, v19
    v_cvt_pk_bf16_f32 v50, v20, v21
    v_cvt_pk_bf16_f32 v51, v22, v23
    buffer_store_dwordx4 v[48:51], v4, s[56:59], s97 offen sc1
    s_cmp_lt_u32 s62, 14
    s_cbranch_scc1 WORKER_A
    s_waitcnt vmcnt(0)
    s_cmp_eq_u32 s4, 0
    s_cselect_b32 s70, 0, 0x7f000000
    v_mov_b32 v7, s69
    v_mov_b32 v239, s70
    s_barrier
    s_mov_b64 exec, 1
    buffer_store_dword v7, v239, s[56:59], s86 offen sc1
    s_mov_b64 exec, -1
    s_lshr_b32 s70, s60, 1
    s_mul_i32 s70, s70, 14
    s_sub_u32 s71, 3, s70
    s_and_b32 s71, s71, 7
    s_lshl_b32 s72, s61, 3
    s_add_u32 s72, s72, s71
    s_cmp_lt_u32 s72, 14
    s_cselect_b32 s71, s72, s71
    s_add_u32 s70, s70, s71
    s_lshl_b32 s70, s70, 7
    s_xor_b32 s76, s70, 128
    s_mul_i32 s71, s4, 12
    s_mul_i32 s72, s4, 16
    s_add_u32 s72, s72, 48
    s_bitcmp1_b32 s60, 0
    s_cselect_b32 s71, s72, s71
    s_mul_i32 s71, s71, 229376
    s_add_u32 s70, s70, s71
    s_bitcmp1_b32 s60, 0
    s_cselect_b32 s71, 7, 3
    s_cselect_b32 s72, 4, 3
    s_cselect_b32 s73, 0xfff20000, 0
    s_mul_i32 s71, s71, 458752
    s_add_u32 s70, s70, s71
    v_lshrrev_b32 v5, 3, v1
    v_mul_u32_u24 v5, 7168, v5
    v_and_b32 v6, 7, v1
    v_lshl_add_u32 v5, v6, 4, v5
    s_mov_b32 s75, s72
HV14:
    buffer_load_dwordx4 v[16:19], v5, s[48:51], s70 offen
    s_add_u32 s70, s70, 57344
    buffer_load_dwordx4 v[20:23], v5, s[48:51], s70 offen
    s_add_u32 s70, s70, 57344
    buffer_load_dwordx4 v[24:27], v5, s[48:51], s70 offen
    s_add_u32 s70, s70, 57344
    buffer_load_dwordx4 v[28:31], v5, s[48:51], s70 offen
    s_add_u32 s70, s70, 57344
    buffer_load_dwordx4 v[32:35], v5, s[48:51], s70 offen
    s_add_u32 s70, s70, 57344
    buffer_load_dwordx4 v[36:39], v5, s[48:51], s70 offen
    s_add_u32 s70, s70, 57344
    buffer_load_dwordx4 v[40:43], v5, s[48:51], s70 offen
    s_add_u32 s70, s70, 57344
    buffer_load_dwordx4 v[44:47], v5, s[48:51], s70 offen
    s_add_u32 s70, s70, 57344
    s_add_u32 s70, s70, s73
    s_sub_u32 s75, s75, 1
    s_cmp_lg_u32 s75, 0
    s_cbranch_scc1 HV14
    s_bitcmp1_b32 s60, 0
    s_cbranch_scc0 HV14X
    s_mul_i32 s71, s4, 2752512
    s_add_u32 s76, s76, s71
    s_add_u32 s76, s76, 14680064
    s_mov_b32 s73, 0
    v_lshrrev_b32 v5, 3, v1
    v_mul_u32_u24 v5, 7168, v5
    v_and_b32 v6, 7, v1
    v_lshl_add_u32 v5, v6, 4, v5
    s_mov_b32 s75, 3
HV14B:
    buffer_load_dwordx4 v[16:19], v5, s[48:51], s76 offen
    s_add_u32 s76, s76, 57344
    buffer_load_dwordx4 v[20:23], v5, s[48:51], s76 offen
    s_add_u32 s76, s76, 57344
    buffer_load_dwordx4 v[24:27], v5, s[48:51], s76 offen
    s_add_u32 s76, s76, 57344
    buffer_load_dwordx4 v[28:31], v5, s[48:51], s76 offen
    s_add_u32 s76, s76, 57344
    buffer_load_dwordx4 v[32:35], v5, s[48:51], s76 offen
    s_add_u32 s76, s76, 57344
    buffer_load_dwordx4 v[36:39], v5, s[48:51], s76 offen
    s_add_u32 s76, s76, 57344
    buffer_load_dwordx4 v[40:43], v5, s[48:51], s76 offen
    s_add_u32 s76, s76, 57344
    buffer_load_dwordx4 v[44:47], v5, s[48:51], s76 offen
    s_add_u32 s76, s76, 57344
    s_add_u32 s76, s76, s73
    s_sub_u32 s75, s75, 1
    s_cmp_lg_u32 s75, 0
    s_cbranch_scc1 HV14B
HV14X:
    s_waitcnt vmcnt(0)
    s_branch FINISH
WORKER_A:
    s_mul_i32 s91, s61, 1835008
    s_add_u32 s91, s91, s90
    s_add_u32 m0, s74, 0
    s_add_u32 s76, s91, 0x0
    buffer_load_dwordx4 v10, s[48:51], s76 offen  lds
    s_add_u32 m0, s74, 1024
    s_add_u32 s76, s91, 0x1c000
    buffer_load_dwordx4 v11, s[48:51], s76 offen  lds
    s_add_u32 m0, s74, 2048
    s_add_u32 s76, s91, 0x38000
    buffer_load_dwordx4 v10, s[48:51], s76 offen  lds
    s_add_u32 m0, s74, 3072
    s_add_u32 s76, s91, 0x54000
    buffer_load_dwordx4 v11, s[48:51], s76 offen  lds
    s_add_u32 s70, s74, 0
    v_add_u32 v232, s70, v4
    s_sub_u32 s71, s4, 1
    s_and_b32 s71, s71, 3
    s_mul_i32 s71, s71, 40960
    s_add_u32 s71, s71, 0
    v_add_u32 v233, s71, v4
    s_sub_u32 s71, s4, 2
    s_and_b32 s71, s71, 3
    s_mul_i32 s71, s71, 40960
    s_add_u32 s71, s71, 4096
    v_add_u32 v234, s71, v4
    s_sub_u32 s71, s4, 3
    s_and_b32 s71, s71, 3
    s_mul_i32 s71, s71, 40960
    s_add_u32 s71, s71, 8192
    v_add_u32 v235, s71, v4
    s_mul_i32 s70, s67, 48
    s_mul_i32 s71, s4, 16
    s_add_u32 s70, s70, s71
    s_lshl_b32 s70, s70, 10
    s_add_u32 s70, s70, 0x100000
    s_mul_i32 s71, s61, 8192
    s_add_u32 s71, s71, 0
    s_add_u32 s36, s70, s71
    s_mul_i32 s71, s61, -8192
    s_add_u32 s71, s71, 8192
    s_add_u32 s37, s70, s71
    s_lshl_b32 s70, s61, 1
    s_add_u32 s41, s70, 1
    s_xor_b32 s40, s41, 1
    s_lshl_b32 s41, s41, 2
    s_lshl_b32 s40, s40, 2
    s_add_u32 s3, s4, s68
    s_mul_i32 s70, s61, 56
    s_add_u32 s70, s70, s68
    s_lshl_b32 s70, s70, 1
    s_add_u32 s70, s70, s67
    s_lshl_b32 s70, s70, 2
    s_add_u32 s70, s70, s4
    s_xor_b32 s71, s70, 4
    s_lshl_b32 s94, s70, 12
    s_add_u32 s94, s94, 0x400000
    s_lshl_b32 s95, s71, 12
    s_add_u32 s95, s95, 0x400000
    s_mul_i32 s70, s5, 37
    s_add_u32 s70, s70, 11
    s_add_u32 s71, s70, 0
    s_and_b32 s71, s71, 0xff
    v_mov_b32 v224, s71
    s_mov_b32 s43, s71
    s_add_u32 s71, s70, 64
    s_and_b32 s71, s71, 0xff
    v_mov_b32 v225, s71
    s_lshl_b32 s71, s71, 8
    s_or_b32 s43, s43, s71
    s_add_u32 s71, s70, 128
    s_and_b32 s71, s71, 0xff
    v_mov_b32 v226, s71
    s_lshl_b32 s71, s71, 16
    s_or_b32 s43, s43, s71
    s_add_u32 s71, s70, 192
    s_and_b32 s71, s71, 0xff
    v_mov_b32 v227, s71
    s_lshl_b32 s71, s71, 24
    s_or_b32 s43, s43, s71
    v_mov_b32 v228, 0xff
    v_mov_b32 v229, 0x0c0c0400
    v_mov_b32 v230, 0x04000c0c
    s_and_b32 s71, s3, 3
    s_add_u32 s71, s71, s41
    s_mul_i32 s71, s71, 114688
    s_lshl_b32 s70, s68, 7
    s_add_u32 s96, s71, s70
    v_mul_u32_u24 v5, 7168, v3
    v_and_b32 v6, 1, v2
    v_lshl_add_u32 v5, v6, 5, v5
    v_lshrrev_b32 v6, 1, v2
    v_lshl_add_u32 v5, v6, 4, v5
    s_waitcnt vmcnt(4)
    s_cmp_eq_u32 s4, 0
    s_cselect_b32 s70, 0, 0x7f000000
    v_mov_b32 v7, s69
    v_mov_b32 v239, s70
    s_barrier
    s_mov_b64 exec, 1
    buffer_store_dword v7, v239, s[56:59], s86 offen sc1
    s_mov_b64 exec, -1
    s_mul_i32 s91, s61, 1835008
    s_add_u32 s91, s91, s90
    s_add_u32 m0, s74, 4096
    s_add_u32 s76, s91, 0xe000
    buffer_load_dwordx4 v10, s[48:51], s76 offen  lds
    s_add_u32 m0, s74, 5120
    s_add_u32 s76, s91, 0x2a000
    buffer_load_dwordx4 v11, s[48:51], s76 offen  lds
    s_add_u32 m0, s74, 6144
    s_add_u32 s76, s91, 0x46000
    buffer_load_dwordx4 v10, s[48:51], s76 offen  lds
    s_add_u32 m0, s74, 7168
    s_add_u32 s76, s91, 0x62000
    buffer_load_dwordx4 v11, s[48:51], s76 offen  lds
    s_mul_i32 s91, s61, 1835008
    s_add_u32 s91, s91, s90
    s_add_u32 m0, s74, 8192
    s_add_u32 s76, s91, 0x70000
    buffer_load_dwordx4 v10, s[48:51], s76 offen  lds
    s_add_u32 m0, s74, 9216
    s_add_u32 s76, s91, 0x8c000
    buffer_load_dwordx4 v11, s[48:51], s76 offen  lds
    s_add_u32 m0, s74, 10240
    s_add_u32 s76, s91, 0xa8000
    buffer_load_dwordx4 v10, s[48:51], s76 offen  lds
    s_waitcnt vmcnt(8)
    ds_read_b64_tr_b16 a[64:65], v12 offset:0
    ds_read_b64_tr_b16 a[66:67], v12 offset:512
    ds_read_b64_tr_b16 a[68:69], v13 offset:0
    ds_read_b64_tr_b16 a[70:71], v13 offset:512
    ds_read_b64_tr_b16 a[72:73], v14 offset:0
    ds_read_b64_tr_b16 a[74:75], v14 offset:512
    ds_read_b64_tr_b16 a[76:77], v15 offset:0
    ds_read_b64_tr_b16 a[78:79], v15 offset:512
    s_add_u32 m0, s74, 11264
    s_add_u32 s76, s91, 0xc4000
    buffer_load_dwordx4 v11, s[48:51], s76 offen  lds
    s_mul_i32 s91, s61, 1835008
    s_add_u32 s91, s91, s90
    s_add_u32 m0, s74, 12288
    s_add_u32 s76, s91, 0x7e000
    buffer_load_dwordx4 v10, s[48:51], s76 offen  lds
    s_add_u32 m0, s74, 13312
    s_add_u32 s76, s91, 0x9a000
    buffer_load_dwordx4 v11, s[48:51], s76 offen  lds
    s_add_u32 m0, s74, 14336
    s_add_u32 s76, s91, 0xb6000
    buffer_load_dwordx4 v10, s[48:51], s76 offen  lds
    s_waitcnt vmcnt(7)
    s_waitcnt lgkmcnt(0)
    ds_read_b64_tr_b16 a[80:81], v12 offset:4096
    ds_read_b64_tr_b16 a[82:83], v12 offset:4608
    ds_read_b64_tr_b16 a[84:85], v13 offset:4096
    ds_read_b64_tr_b16 a[86:87], v13 offset:4608
    ds_read_b64_tr_b16 a[88:89], v14 offset:4096
    ds_read_b64_tr_b16 a[90:91], v14 offset:4608
    ds_read_b64_tr_b16 a[92:93], v15 offset:4096
    ds_read_b64_tr_b16 a[94:95], v15 offset:4608
    s_add_u32 m0, s74, 15360
    s_add_u32 s76, s91, 0xd2000
    buffer_load_dwordx4 v11, s[48:51], s76 offen  lds
    s_mul_i32 s91, s61, 1835008
    s_add_u32 s91, s91, s90
    s_add_u32 m0, s74, 16384
    s_add_u32 s76, s91, 0xe0000
    buffer_load_dwordx4 v10, s[48:51], s76 offen  lds
    s_add_u32 m0, s74, 17408
    s_add_u32 s76, s91, 0xfc000
    buffer_load_dwordx4 v11, s[48:51], s76 offen  lds
    s_add_u32 m0, s74, 18432
    s_add_u32 s76, s91, 0x118000
    buffer_load_dwordx4 v10, s[48:51], s76 offen  lds
    s_add_u32 m0, s74, 19456
    s_add_u32 s76, s91, 0x134000
    buffer_load_dwordx4 v11, s[48:51], s76 offen  lds
    s_waitcnt vmcnt(8)
    s_waitcnt lgkmcnt(0)
    ds_read_b64_tr_b16 a[96:97], v12 offset:8192
    ds_read_b64_tr_b16 a[98:99], v12 offset:8704
    ds_read_b64_tr_b16 a[100:101], v13 offset:8192
    ds_read_b64_tr_b16 a[102:103], v13 offset:8704
    ds_read_b64_tr_b16 a[104:105], v14 offset:8192
    ds_read_b64_tr_b16 a[106:107], v14 offset:8704
    ds_read_b64_tr_b16 a[108:109], v15 offset:8192
    ds_read_b64_tr_b16 a[110:111], v15 offset:8704
    s_mul_i32 s91, s61, 1835008
    s_add_u32 s91, s91, s90
    s_add_u32 m0, s74, 0
    s_add_u32 s76, s91, 0xee000
    buffer_load_dwordx4 v10, s[48:51], s76 offen  lds
    s_add_u32 m0, s74, 1024
    s_add_u32 s76, s91, 0x10a000
    buffer_load_dwordx4 v11, s[48:51], s76 offen  lds
    s_add_u32 m0, s74, 2048
    s_add_u32 s76, s91, 0x126000
    buffer_load_dwordx4 v10, s[48:51], s76 offen  lds
    s_add_u32 m0, s74, 3072
    s_add_u32 s76, s91, 0x142000
    buffer_load_dwordx4 v11, s[48:51], s76 offen  lds
    s_waitcnt vmcnt(8)
    s_waitcnt lgkmcnt(0)
    ds_read_b64_tr_b16 a[112:113], v12 offset:12288
    ds_read_b64_tr_b16 a[114:115], v12 offset:12800
    ds_read_b64_tr_b16 a[116:117], v13 offset:12288
    ds_read_b64_tr_b16 a[118:119], v13 offset:12800
    ds_read_b64_tr_b16 a[120:121], v14 offset:12288
    ds_read_b64_tr_b16 a[122:123], v14 offset:12800
    ds_read_b64_tr_b16 a[124:125], v15 offset:12288
    ds_read_b64_tr_b16 a[126:127], v15 offset:12800
    s_mul_i32 s91, s61, 1835008
    s_add_u32 s91, s91, s90
    s_add_u32 m0, s74, 4096
    s_add_u32 s76, s91, 0x150000
    buffer_load_dwordx4 v10, s[48:51], s76 offen  lds
    s_add_u32 m0, s74, 5120
    s_add_u32 s76, s91, 0x16c000
    buffer_load_dwordx4 v11, s[48:51], s76 offen  lds
    s_add_u32 m0, s74, 6144
    s_add_u32 s76, s91, 0x188000
    buffer_load_dwordx4 v10, s[48:51], s76 offen  lds
    s_add_u32 m0, s74, 7168
    s_add_u32 s76, s91, 0x1a4000
    buffer_load_dwordx4 v11, s[48:51], s76 offen  lds
    s_waitcnt vmcnt(8)
    s_waitcnt lgkmcnt(0)
    ds_read_b64_tr_b16 a[128:129], v12 offset:16384
    ds_read_b64_tr_b16 a[130:131], v12 offset:16896
    ds_read_b64_tr_b16 a[132:133], v13 offset:16384
    ds_read_b64_tr_b16 a[134:135], v13 offset:16896
    ds_read_b64_tr_b16 a[136:137], v14 offset:16384
    ds_read_b64_tr_b16 a[138:139], v14 offset:16896
    ds_read_b64_tr_b16 a[140:141], v15 offset:16384
    ds_read_b64_tr_b16 a[142:143], v15 offset:16896
    s_mul_i32 s91, s61, 1835008
    s_add_u32 s91, s91, s90
    s_add_u32 m0, s74, 8192
    s_add_u32 s76, s91, 0x15e000
    buffer_load_dwordx4 v10, s[48:51], s76 offen  lds
    s_add_u32 m0, s74, 9216
    s_add_u32 s76, s91, 0x17a000
    buffer_load_dwordx4 v11, s[48:51], s76 offen  lds
    s_add_u32 m0, s74, 10240
    s_add_u32 s76, s91, 0x196000
    buffer_load_dwordx4 v10, s[48:51], s76 offen  lds
    s_add_u32 m0, s74, 11264
    s_add_u32 s76, s91, 0x1b2000
    buffer_load_dwordx4 v11, s[48:51], s76 offen  lds
    s_waitcnt vmcnt(8)
    s_waitcnt lgkmcnt(0)
    ds_read_b64_tr_b16 a[144:145], v12 offset:0
    ds_read_b64_tr_b16 a[146:147], v12 offset:512
    ds_read_b64_tr_b16 a[148:149], v13 offset:0
    ds_read_b64_tr_b16 a[150:151], v13 offset:512
    ds_read_b64_tr_b16 a[152:153], v14 offset:0
    ds_read_b64_tr_b16 a[154:155], v14 offset:512
    ds_read_b64_tr_b16 a[156:157], v15 offset:0
    ds_read_b64_tr_b16 a[158:159], v15 offset:512
    s_mul_i32 s91, s61, -1835008
    s_add_u32 s91, s91, s90
    s_add_u32 m0, s74, 12288
    s_add_u32 s76, s91, 0x1c0000
    buffer_load_dwordx4 v10, s[48:51], s76 offen nt lds
    s_add_u32 m0, s74, 13312
    s_add_u32 s76, s91, 0x1dc000
    buffer_load_dwordx4 v11, s[48:51], s76 offen nt lds
    s_add_u32 m0, s74, 14336
    s_add_u32 s76, s91, 0x1f8000
    buffer_load_dwordx4 v10, s[48:51], s76 offen nt lds
    s_add_u32 m0, s74, 15360
    s_add_u32 s76, s91, 0x214000
    buffer_load_dwordx4 v11, s[48:51], s76 offen nt lds
    s_waitcnt vmcnt(8)
    s_waitcnt lgkmcnt(0)
    ds_read_b64_tr_b16 a[160:161], v12 offset:4096
    ds_read_b64_tr_b16 a[162:163], v12 offset:4608
    ds_read_b64_tr_b16 a[164:165], v13 offset:4096
    ds_read_b64_tr_b16 a[166:167], v13 offset:4608
    ds_read_b64_tr_b16 a[168:169], v14 offset:4096
    ds_read_b64_tr_b16 a[170:171], v14 offset:4608
    ds_read_b64_tr_b16 a[172:173], v15 offset:4096
    ds_read_b64_tr_b16 a[174:175], v15 offset:4608
    s_mul_i32 s91, s61, -1835008
    s_add_u32 s91, s91, s90
    s_add_u32 m0, s74, 16384
    s_add_u32 s76, s91, 0x1ce000
    buffer_load_dwordx4 v10, s[48:51], s76 offen nt lds
    s_add_u32 m0, s74, 17408
    s_add_u32 s76, s91, 0x1ea000
    buffer_load_dwordx4 v11, s[48:51], s76 offen nt lds
    s_add_u32 m0, s74, 18432
    s_add_u32 s76, s91, 0x206000
    buffer_load_dwordx4 v10, s[48:51], s76 offen nt lds
    s_add_u32 m0, s74, 19456
    s_add_u32 s76, s91, 0x222000
    buffer_load_dwordx4 v11, s[48:51], s76 offen nt lds
    s_waitcnt vmcnt(8)
    s_waitcnt lgkmcnt(0)
    ds_read_b64_tr_b16 a[176:177], v12 offset:8192
    ds_read_b64_tr_b16 a[178:179], v12 offset:8704
    ds_read_b64_tr_b16 a[180:181], v13 offset:8192
    ds_read_b64_tr_b16 a[182:183], v13 offset:8704
    ds_read_b64_tr_b16 a[184:185], v14 offset:8192
    ds_read_b64_tr_b16 a[186:187], v14 offset:8704
    ds_read_b64_tr_b16 a[188:189], v15 offset:8192
    ds_read_b64_tr_b16 a[190:191], v15 offset:8704
    s_mul_i32 s91, s61, -1835008
    s_add_u32 s91, s91, s90
    s_add_u32 m0, s74, 0
    s_add_u32 s76, s91, 0x230000
    buffer_load_dwordx4 v10, s[48:51], s76 offen nt lds
    s_add_u32 m0, s74, 1024
    s_add_u32 s76, s91, 0x24c000
    buffer_load_dwordx4 v11, s[48:51], s76 offen nt lds
    s_add_u32 m0, s74, 2048
    s_add_u32 s76, s91, 0x268000
    buffer_load_dwordx4 v10, s[48:51], s76 offen nt lds
    s_add_u32 m0, s74, 3072
    s_add_u32 s76, s91, 0x284000
    buffer_load_dwordx4 v11, s[48:51], s76 offen nt lds
    s_waitcnt vmcnt(8)
    s_waitcnt lgkmcnt(0)
    ds_read_b64_tr_b16 a[192:193], v12 offset:12288
    ds_read_b64_tr_b16 a[194:195], v12 offset:12800
    ds_read_b64_tr_b16 a[196:197], v13 offset:12288
    ds_read_b64_tr_b16 a[198:199], v13 offset:12800
    ds_read_b64_tr_b16 a[200:201], v14 offset:12288
    ds_read_b64_tr_b16 a[202:203], v14 offset:12800
    ds_read_b64_tr_b16 a[204:205], v15 offset:12288
    ds_read_b64_tr_b16 a[206:207], v15 offset:12800
    s_mul_i32 s91, s61, -1835008
    s_add_u32 s91, s91, s90
    s_add_u32 m0, s74, 4096
    s_add_u32 s76, s91, 0x23e000
    buffer_load_dwordx4 v10, s[48:51], s76 offen nt lds
    s_add_u32 m0, s74, 5120
    s_add_u32 s76, s91, 0x25a000
    buffer_load_dwordx4 v11, s[48:51], s76 offen nt lds
    s_add_u32 m0, s74, 6144
    s_add_u32 s76, s91, 0x276000
    buffer_load_dwordx4 v10, s[48:51], s76 offen nt lds
    s_add_u32 m0, s74, 7168
    s_add_u32 s76, s91, 0x292000
    buffer_load_dwordx4 v11, s[48:51], s76 offen nt lds
    s_waitcnt vmcnt(8)
    s_waitcnt lgkmcnt(0)
    ds_read_b64_tr_b16 a[208:209], v12 offset:16384
    ds_read_b64_tr_b16 a[210:211], v12 offset:16896
    ds_read_b64_tr_b16 a[212:213], v13 offset:16384
    ds_read_b64_tr_b16 a[214:215], v13 offset:16896
    ds_read_b64_tr_b16 a[216:217], v14 offset:16384
    ds_read_b64_tr_b16 a[218:219], v14 offset:16896
    ds_read_b64_tr_b16 a[220:221], v15 offset:16384
    ds_read_b64_tr_b16 a[222:223], v15 offset:16896
    s_mul_i32 s91, s61, 1376256
    s_add_u32 s91, s91, s78
    s_add_u32 s76, s91, 0xee000
    buffer_load_dwordx4 v[144:147], v236, s[48:51], s76 offen
    s_add_u32 s76, s91, 0x10a000
    buffer_load_dwordx4 v[148:151], v236, s[48:51], s76 offen
    s_add_u32 s76, s91, 0x126000
    buffer_load_dwordx4 v[152:155], v236, s[48:51], s76 offen
    s_add_u32 s76, s91, 0x142000
    buffer_load_dwordx4 v[156:159], v236, s[48:51], s76 offen
    s_waitcnt vmcnt(8)
    s_waitcnt lgkmcnt(0)
    ds_read_b64_tr_b16 a[0:1], v12 offset:0
    ds_read_b64_tr_b16 a[2:3], v12 offset:512
    ds_read_b64_tr_b16 a[4:5], v13 offset:0
    ds_read_b64_tr_b16 a[6:7], v13 offset:512
    ds_read_b64_tr_b16 a[8:9], v14 offset:0
    ds_read_b64_tr_b16 a[10:11], v14 offset:512
    ds_read_b64_tr_b16 a[12:13], v15 offset:0
    ds_read_b64_tr_b16 a[14:15], v15 offset:512
    s_mul_i32 s91, s61, 1376256
    s_add_u32 s91, s91, s78
    s_add_u32 s76, s91, 0xe0000
    buffer_load_dwordx4 v[144:147], v236, s[48:51], s76 offen
    s_add_u32 s76, s91, 0xfc000
    buffer_load_dwordx4 v[148:151], v236, s[48:51], s76 offen
    s_add_u32 s76, s91, 0x118000
    buffer_load_dwordx4 v[152:155], v236, s[48:51], s76 offen
    s_add_u32 s76, s91, 0x134000
    buffer_load_dwordx4 v[156:159], v236, s[48:51], s76 offen
    s_waitcnt vmcnt(8)
    s_waitcnt lgkmcnt(0)
    ds_read_b64_tr_b16 a[16:17], v12 offset:4096
    ds_read_b64_tr_b16 a[18:19], v12 offset:4608
    ds_read_b64_tr_b16 a[20:21], v13 offset:4096
    ds_read_b64_tr_b16 a[22:23], v13 offset:4608
    ds_read_b64_tr_b16 a[24:25], v14 offset:4096
    ds_read_b64_tr_b16 a[26:27], v14 offset:4608
    ds_read_b64_tr_b16 a[28:29], v15 offset:4096
    ds_read_b64_tr_b16 a[30:31], v15 offset:4608
    s_mul_i32 s91, s61, 1376256
    s_add_u32 s91, s91, s78
    s_add_u32 s76, s91, 0x7e000
    buffer_load_dwordx4 v[144:147], v236, s[48:51], s76 offen
    s_add_u32 s76, s91, 0x9a000
    buffer_load_dwordx4 v[148:151], v236, s[48:51], s76 offen
    s_add_u32 s76, s91, 0xb6000
    buffer_load_dwordx4 v[152:155], v236, s[48:51], s76 offen
    s_add_u32 s76, s91, 0xd2000
    buffer_load_dwordx4 v[156:159], v236, s[48:51], s76 offen
    s_waitcnt vmcnt(8)
    s_mul_i32 s91, s61, 1376256
    s_add_u32 s91, s91, s78
    s_add_u32 s76, s91, 0x70000
    buffer_load_dwordx4 v[144:147], v236, s[48:51], s76 offen
    s_add_u32 s76, s91, 0x8c000
    buffer_load_dwordx4 v[148:151], v236, s[48:51], s76 offen
    s_add_u32 s76, s91, 0xa8000
    buffer_load_dwordx4 v[152:155], v236, s[48:51], s76 offen
    s_add_u32 s76, s91, 0xc4000
    buffer_load_dwordx4 v[156:159], v236, s[48:51], s76 offen
    s_waitcnt vmcnt(8)
    s_mul_i32 s91, s61, 1376256
    s_add_u32 s91, s91, s78
    s_add_u32 s76, s91, 0xe000
    buffer_load_dwordx4 v[144:147], v236, s[48:51], s76 offen
    s_add_u32 s76, s91, 0x2a000
    buffer_load_dwordx4 v[148:151], v236, s[48:51], s76 offen
    s_add_u32 s76, s91, 0x46000
    buffer_load_dwordx4 v[152:155], v236, s[48:51], s76 offen
    s_add_u32 s76, s91, 0x62000
    buffer_load_dwordx4 v[156:159], v236, s[48:51], s76 offen
    s_waitcnt vmcnt(8)
    s_mul_i32 s91, s61, 1376256
    s_add_u32 s91, s91, s78
    s_add_u32 s76, s91, 0x0
    buffer_load_dwordx4 v[144:147], v236, s[48:51], s76 offen
    s_add_u32 s76, s91, 0x1c000
    buffer_load_dwordx4 v[148:151], v236, s[48:51], s76 offen
    s_add_u32 s76, s91, 0x38000
    buffer_load_dwordx4 v[152:155], v236, s[48:51], s76 offen
    s_add_u32 s76, s91, 0x54000
    buffer_load_dwordx4 v[156:159], v236, s[48:51], s76 offen
    s_waitcnt vmcnt(8)
    s_mul_i32 s91, s61, -1835008
    s_add_u32 s91, s91, s90
    s_add_u32 m0, s74, 8192
    s_add_u32 s76, s91, 0x2a0000
    buffer_load_dwordx4 v10, s[48:51], s76 offen nt lds
    s_add_u32 m0, s74, 9216
    s_add_u32 s76, s91, 0x2bc000
    buffer_load_dwordx4 v11, s[48:51], s76 offen nt lds
    s_add_u32 m0, s74, 10240
    s_add_u32 s76, s91, 0x2d8000
    buffer_load_dwordx4 v10, s[48:51], s76 offen nt lds
    s_add_u32 m0, s74, 11264
    s_add_u32 s76, s91, 0x2f4000
    buffer_load_dwordx4 v11, s[48:51], s76 offen nt lds
    s_waitcnt vmcnt(8)
    s_mul_i32 s91, s61, -1835008
    s_add_u32 s91, s91, s90
    s_add_u32 m0, s74, 12288
    s_add_u32 s76, s91, 0x2ae000
    buffer_load_dwordx4 v10, s[48:51], s76 offen nt lds
    s_add_u32 m0, s74, 13312
    s_add_u32 s76, s91, 0x2ca000
    buffer_load_dwordx4 v11, s[48:51], s76 offen nt lds
    s_add_u32 m0, s74, 14336
    s_add_u32 s76, s91, 0x2e6000
    buffer_load_dwordx4 v10, s[48:51], s76 offen nt lds
    s_add_u32 m0, s74, 15360
    s_add_u32 s76, s91, 0x302000
    buffer_load_dwordx4 v11, s[48:51], s76 offen nt lds
    s_waitcnt vmcnt(8)
    s_mul_i32 s91, s61, -1835008
    s_add_u32 s91, s91, s90
    s_add_u32 m0, s74, 16384
    s_add_u32 s76, s91, 0x310000
    buffer_load_dwordx4 v10, s[48:51], s76 offen nt lds
    s_add_u32 m0, s74, 17408
    s_add_u32 s76, s91, 0x32c000
    buffer_load_dwordx4 v11, s[48:51], s76 offen nt lds
    s_add_u32 m0, s74, 18432
    s_add_u32 s76, s91, 0x348000
    buffer_load_dwordx4 v10, s[48:51], s76 offen nt lds
    s_add_u32 m0, s74, 19456
    s_add_u32 s76, s91, 0x364000
    buffer_load_dwordx4 v11, s[48:51], s76 offen nt lds
    s_waitcnt vmcnt(8)
    s_waitcnt lgkmcnt(0)
    ds_read_b64_tr_b16 a[32:33], v12 offset:8192
    ds_read_b64_tr_b16 a[34:35], v12 offset:8704
    ds_read_b64_tr_b16 a[36:37], v13 offset:8192
    ds_read_b64_tr_b16 a[38:39], v13 offset:8704
    ds_read_b64_tr_b16 a[40:41], v14 offset:8192
    ds_read_b64_tr_b16 a[42:43], v14 offset:8704
    ds_read_b64_tr_b16 a[44:45], v15 offset:8192
    ds_read_b64_tr_b16 a[46:47], v15 offset:8704
    s_mul_i32 s91, s61, -1835008
    s_add_u32 s91, s91, s90
    s_add_u32 m0, s74, 0
    s_add_u32 s76, s91, 0x31e000
    buffer_load_dwordx4 v10, s[48:51], s76 offen nt lds
    s_add_u32 m0, s74, 1024
    s_add_u32 s76, s91, 0x33a000
    buffer_load_dwordx4 v11, s[48:51], s76 offen nt lds
    s_add_u32 m0, s74, 2048
    s_add_u32 s76, s91, 0x356000
    buffer_load_dwordx4 v10, s[48:51], s76 offen nt lds
    s_add_u32 m0, s74, 3072
    s_add_u32 s76, s91, 0x372000
    buffer_load_dwordx4 v11, s[48:51], s76 offen nt lds
    s_waitcnt vmcnt(8)
    s_waitcnt lgkmcnt(0)
    ds_read_b64_tr_b16 a[48:49], v12 offset:12288
    ds_read_b64_tr_b16 a[50:51], v12 offset:12800
    ds_read_b64_tr_b16 a[52:53], v13 offset:12288
    ds_read_b64_tr_b16 a[54:55], v13 offset:12800
    ds_read_b64_tr_b16 a[56:57], v14 offset:12288
    ds_read_b64_tr_b16 a[58:59], v14 offset:12800
    ds_read_b64_tr_b16 a[60:61], v15 offset:12288
    ds_read_b64_tr_b16 a[62:63], v15 offset:12800
    buffer_load_dword v238, v237, s[56:59], s6 offen sc1
    s_waitcnt vmcnt(5)
    s_waitcnt lgkmcnt(0)
    ds_read_b64_tr_b16 v[112:113], v12 offset:16384
    ds_read_b64_tr_b16 v[114:115], v12 offset:16896
    ds_read_b64_tr_b16 v[116:117], v13 offset:16384
    ds_read_b64_tr_b16 v[118:119], v13 offset:16896
    ds_read_b64_tr_b16 v[120:121], v14 offset:16384
    ds_read_b64_tr_b16 v[122:123], v14 offset:16896
    ds_read_b64_tr_b16 v[124:125], v15 offset:16384
    ds_read_b64_tr_b16 v[126:127], v15 offset:16896
    s_waitcnt vmcnt(1)
    s_waitcnt lgkmcnt(0)
    ds_read_b64_tr_b16 v[128:129], v12 offset:0
    ds_read_b64_tr_b16 v[130:131], v12 offset:512
    ds_read_b64_tr_b16 v[132:133], v13 offset:0
    ds_read_b64_tr_b16 v[134:135], v13 offset:512
    ds_read_b64_tr_b16 v[136:137], v14 offset:0
    ds_read_b64_tr_b16 v[138:139], v14 offset:512
    ds_read_b64_tr_b16 v[140:141], v15 offset:0
    ds_read_b64_tr_b16 v[142:143], v15 offset:512
    s_waitcnt lgkmcnt(0)
    s_waitcnt vmcnt(0)
    v_cmp_ne_u32 vcc, s69, v238
    s_mov_b32 s75, 0
    s_cbranch_vccz POLLX_2
POLL_1:
    s_sleep 8
    buffer_load_dword v238, v237, s[56:59], s6 offen sc1
    s_add_u32 s75, s75, 1
    s_waitcnt vmcnt(0)
    v_cmp_ne_u32 vcc, s69, v238
    s_cmp_gt_u32 s75, 0x40000
    s_cbranch_scc1 POLLX_2
    s_cbranch_vccnz POLL_1
POLLX_2:
    s_add_u32 s42, s3, 1
    s_and_b32 s42, s42, 3
    s_add_u32 s42, s42, s40
    s_mul_i32 s42, s42, 114688
    s_add_u32 s76, s42, s36
    buffer_load_dwordx4 v[16:19], v4, s[56:59], s76 offen offset:0 sc1
    buffer_load_dwordx4 v[20:23], v4, s[56:59], s76 offen offset:1024 sc1
    buffer_load_dwordx4 v[24:27], v4, s[56:59], s76 offen offset:2048 sc1
    buffer_load_dwordx4 v[28:31], v4, s[56:59], s76 offen offset:3072 sc1
    s_add_u32 s76, s76, 4096
    buffer_load_dwordx4 v[32:35], v4, s[56:59], s76 offen offset:0 sc1
    buffer_load_dwordx4 v[36:39], v4, s[56:59], s76 offen offset:1024 sc1
    buffer_load_dwordx4 v[40:43], v4, s[56:59], s76 offen offset:2048 sc1
    buffer_load_dwordx4 v[44:47], v4, s[56:59], s76 offen offset:3072 sc1
    s_add_u32 s76, s42, s37
    buffer_load_dwordx4 v[48:51], v4, s[56:59], s76 offen offset:0 sc1
    buffer_load_dwordx4 v[52:55], v4, s[56:59], s76 offen offset:1024 sc1
    s_waitcnt vmcnt(9)
    v_mfma_f32_16x16x32_bf16 a[224:227], a[64:67], v[16:19], 0
    buffer_load_dwordx4 v[56:59], v4, s[56:59], s76 offen offset:2048 sc1
    v_mfma_f32_16x16x32_bf16 a[228:231], a[68:71], v[16:19], 0
    v_mfma_f32_16x16x32_bf16 a[232:235], a[72:75], v[16:19], 0
    v_mfma_f32_16x16x32_bf16 a[236:239], a[76:79], v[16:19], 0
    s_waitcnt vmcnt(9)
    v_mfma_f32_16x16x32_bf16 a[224:227], a[80:83], v[20:23], a[224:227]
    buffer_load_dwordx4 v[60:63], v4, s[56:59], s76 offen offset:3072 sc1
    v_mfma_f32_16x16x32_bf16 a[228:231], a[84:87], v[20:23], a[228:231]
    v_mfma_f32_16x16x32_bf16 a[232:235], a[88:91], v[20:23], a[232:235]
    v_mfma_f32_16x16x32_bf16 a[236:239], a[92:95], v[20:23], a[236:239]
    s_waitcnt vmcnt(9)
    v_mfma_f32_16x16x32_bf16 a[224:227], a[96:99], v[24:27], a[224:227]
    s_add_u32 s76, s76, 4096
    buffer_load_dwordx4 v[64:67], v4, s[56:59], s76 offen offset:0 sc1
    v_mfma_f32_16x16x32_bf16 a[228:231], a[100:103], v[24:27], a[228:231]
    v_mfma_f32_16x16x32_bf16 a[232:235], a[104:107], v[24:27], a[232:235]
    v_mfma_f32_16x16x32_bf16 a[236:239], a[108:111], v[24:27], a[236:239]
    s_waitcnt vmcnt(9)
    v_mfma_f32_16x16x32_bf16 a[224:227], a[112:115], v[28:31], a[224:227]
    buffer_load_dwordx4 v[68:71], v4, s[56:59], s76 offen offset:1024 sc1
    v_mfma_f32_16x16x32_bf16 a[228:231], a[116:119], v[28:31], a[228:231]
    v_mfma_f32_16x16x32_bf16 a[232:235], a[120:123], v[28:31], a[232:235]
    v_mfma_f32_16x16x32_bf16 a[236:239], a[124:127], v[28:31], a[236:239]
    s_waitcnt vmcnt(9)
    v_mfma_f32_16x16x32_bf16 a[224:227], a[128:131], v[32:35], a[224:227]
    buffer_load_dwordx4 v[72:75], v4, s[56:59], s76 offen offset:2048 sc1
    v_mfma_f32_16x16x32_bf16 a[228:231], a[132:135], v[32:35], a[228:231]
    v_mfma_f32_16x16x32_bf16 a[232:235], a[136:139], v[32:35], a[232:235]
    v_mfma_f32_16x16x32_bf16 a[236:239], a[140:143], v[32:35], a[236:239]
    s_waitcnt vmcnt(9)
    v_mfma_f32_16x16x32_bf16 a[224:227], a[144:147], v[36:39], a[224:227]
    buffer_load_dwordx4 v[76:79], v4, s[56:59], s76 offen offset:3072 sc1
    v_mfma_f32_16x16x32_bf16 a[228:231], a[148:151], v[36:39], a[228:231]
    v_mfma_f32_16x16x32_bf16 a[232:235], a[152:155], v[36:39], a[232:235]
    v_mfma_f32_16x16x32_bf16 a[236:239], a[156:159], v[36:39], a[236:239]
    s_waitcnt vmcnt(9)
    v_mfma_f32_16x16x32_bf16 a[224:227], a[160:163], v[40:43], a[224:227]
    s_add_u32 s42, s3, 2
    s_and_b32 s42, s42, 3
    s_add_u32 s42, s42, s40
    s_mul_i32 s42, s42, 114688
    s_add_u32 s76, s42, s36
    buffer_load_dwordx4 v[80:83], v4, s[56:59], s76 offen offset:0 sc1
    v_mfma_f32_16x16x32_bf16 a[228:231], a[164:167], v[40:43], a[228:231]
    v_mfma_f32_16x16x32_bf16 a[232:235], a[168:171], v[40:43], a[232:235]
    v_mfma_f32_16x16x32_bf16 a[236:239], a[172:175], v[40:43], a[236:239]
    s_waitcnt vmcnt(9)
    v_mfma_f32_16x16x32_bf16 a[224:227], a[176:179], v[44:47], a[224:227]
    buffer_load_dwordx4 v[84:87], v4, s[56:59], s76 offen offset:1024 sc1
    v_mfma_f32_16x16x32_bf16 a[228:231], a[180:183], v[44:47], a[228:231]
    v_mfma_f32_16x16x32_bf16 a[232:235], a[184:187], v[44:47], a[232:235]
    v_mfma_f32_16x16x32_bf16 a[236:239], a[188:191], v[44:47], a[236:239]
    s_waitcnt vmcnt(9)
    v_mfma_f32_16x16x32_bf16 a[224:227], a[192:195], v[48:51], a[224:227]
    buffer_load_dwordx4 v[88:91], v4, s[56:59], s76 offen offset:2048 sc1
    v_mfma_f32_16x16x32_bf16 a[228:231], a[196:199], v[48:51], a[228:231]
    v_mfma_f32_16x16x32_bf16 a[232:235], a[200:203], v[48:51], a[232:235]
    v_mfma_f32_16x16x32_bf16 a[236:239], a[204:207], v[48:51], a[236:239]
    s_waitcnt vmcnt(9)
    v_mfma_f32_16x16x32_bf16 a[224:227], a[208:211], v[52:55], a[224:227]
    buffer_load_dwordx4 v[92:95], v4, s[56:59], s76 offen offset:3072 sc1
    v_mfma_f32_16x16x32_bf16 a[228:231], a[212:215], v[52:55], a[228:231]
    v_mfma_f32_16x16x32_bf16 a[232:235], a[216:219], v[52:55], a[232:235]
    v_mfma_f32_16x16x32_bf16 a[236:239], a[220:223], v[52:55], a[236:239]
    s_waitcnt vmcnt(9)
    v_mfma_f32_16x16x32_bf16 a[224:227], a[0:3], v[56:59], a[224:227]
    s_add_u32 s76, s76, 4096
    buffer_load_dwordx4 v[96:99], v4, s[56:59], s76 offen offset:0 sc1
    v_mfma_f32_16x16x32_bf16 a[228:231], a[4:7], v[56:59], a[228:231]
    v_mfma_f32_16x16x32_bf16 a[232:235], a[8:11], v[56:59], a[232:235]
    v_mfma_f32_16x16x32_bf16 a[236:239], a[12:15], v[56:59], a[236:239]
    s_waitcnt vmcnt(9)
    v_mfma_f32_16x16x32_bf16 a[224:227], a[16:19], v[60:63], a[224:227]
    buffer_load_dwordx4 v[100:103], v4, s[56:59], s76 offen offset:1024 sc1
    v_mfma_f32_16x16x32_bf16 a[228:231], a[20:23], v[60:63], a[228:231]
    v_mfma_f32_16x16x32_bf16 a[232:235], a[24:27], v[60:63], a[232:235]
    v_mfma_f32_16x16x32_bf16 a[236:239], a[28:31], v[60:63], a[236:239]
    s_waitcnt vmcnt(9)
    v_mfma_f32_16x16x32_bf16 a[224:227], a[32:35], v[64:67], a[224:227]
    buffer_load_dwordx4 v[104:107], v4, s[56:59], s76 offen offset:2048 sc1
    v_mfma_f32_16x16x32_bf16 a[228:231], a[36:39], v[64:67], a[228:231]
    v_mfma_f32_16x16x32_bf16 a[232:235], a[40:43], v[64:67], a[232:235]
    v_mfma_f32_16x16x32_bf16 a[236:239], a[44:47], v[64:67], a[236:239]
    s_waitcnt vmcnt(9)
    v_mfma_f32_16x16x32_bf16 a[224:227], a[48:51], v[68:71], a[224:227]
    buffer_load_dwordx4 v[108:111], v4, s[56:59], s76 offen offset:3072 sc1
    v_mfma_f32_16x16x32_bf16 a[228:231], a[52:55], v[68:71], a[228:231]
    v_mfma_f32_16x16x32_bf16 a[232:235], a[56:59], v[68:71], a[232:235]
    v_mfma_f32_16x16x32_bf16 a[236:239], a[60:63], v[68:71], a[236:239]
    s_waitcnt vmcnt(9)
    v_mfma_f32_16x16x32_bf16 a[224:227], v[112:115], v[72:75], a[224:227]
    s_add_u32 s76, s42, s37
    buffer_load_dwordx4 v[16:19], v4, s[56:59], s76 offen offset:0 sc1
    v_mfma_f32_16x16x32_bf16 a[228:231], v[116:119], v[72:75], a[228:231]
    v_mfma_f32_16x16x32_bf16 a[232:235], v[120:123], v[72:75], a[232:235]
    v_mfma_f32_16x16x32_bf16 a[236:239], v[124:127], v[72:75], a[236:239]
    s_waitcnt vmcnt(9)
    v_mfma_f32_16x16x32_bf16 a[224:227], v[128:131], v[76:79], a[224:227]
    buffer_load_dwordx4 v[20:23], v4, s[56:59], s76 offen offset:1024 sc1
    v_mfma_f32_16x16x32_bf16 a[228:231], v[132:135], v[76:79], a[228:231]
    v_mfma_f32_16x16x32_bf16 a[232:235], v[136:139], v[76:79], a[232:235]
    v_mfma_f32_16x16x32_bf16 a[236:239], v[140:143], v[76:79], a[236:239]
    s_waitcnt vmcnt(9)
    v_mfma_f32_16x16x32_bf16 a[240:243], a[64:67], v[80:83], 0
    buffer_load_dwordx4 v[24:27], v4, s[56:59], s76 offen offset:2048 sc1
    v_mfma_f32_16x16x32_bf16 a[244:247], a[68:71], v[80:83], 0
    v_mfma_f32_16x16x32_bf16 a[248:251], a[72:75], v[80:83], 0
    v_mfma_f32_16x16x32_bf16 a[252:255], a[76:79], v[80:83], 0
    s_waitcnt vmcnt(9)
    v_mfma_f32_16x16x32_bf16 a[240:243], a[80:83], v[84:87], a[240:243]
    buffer_load_dwordx4 v[28:31], v4, s[56:59], s76 offen offset:3072 sc1
    v_mfma_f32_16x16x32_bf16 a[244:247], a[84:87], v[84:87], a[244:247]
    v_mfma_f32_16x16x32_bf16 a[248:251], a[88:91], v[84:87], a[248:251]
    v_mfma_f32_16x16x32_bf16 a[252:255], a[92:95], v[84:87], a[252:255]
    s_waitcnt vmcnt(9)
    v_mfma_f32_16x16x32_bf16 a[240:243], a[96:99], v[88:91], a[240:243]
    s_add_u32 s76, s76, 4096
    buffer_load_dwordx4 v[32:35], v4, s[56:59], s76 offen offset:0 sc1
    v_mfma_f32_16x16x32_bf16 a[244:247], a[100:103], v[88:91], a[244:247]
    ds_write_b128 v232, a[224:227] offset:0

    v_mfma_f32_16x16x32_bf16 a[248:251], a[104:107], v[88:91], a[248:251]
    ds_write_b128 v232, a[228:231] offset:1024

    v_mfma_f32_16x16x32_bf16 a[252:255], a[108:111], v[88:91], a[252:255]
    ds_write_b128 v232, a[232:235] offset:2048

    s_waitcnt vmcnt(9)
    v_mfma_f32_16x16x32_bf16 a[240:243], a[112:115], v[92:95], a[240:243]
    buffer_load_dwordx4 v[36:39], v4, s[56:59], s76 offen offset:1024 sc1
    v_mfma_f32_16x16x32_bf16 a[244:247], a[116:119], v[92:95], a[244:247]
    ds_write_b128 v232, a[236:239] offset:3072

    v_mfma_f32_16x16x32_bf16 a[248:251], a[120:123], v[92:95], a[248:251]
    v_mfma_f32_16x16x32_bf16 a[252:255], a[124:127], v[92:95], a[252:255]
    s_waitcnt vmcnt(9)
    v_mfma_f32_16x16x32_bf16 a[240:243], a[128:131], v[96:99], a[240:243]
    buffer_load_dwordx4 v[40:43], v4, s[56:59], s76 offen offset:2048 sc1
    v_mfma_f32_16x16x32_bf16 a[244:247], a[132:135], v[96:99], a[244:247]
    v_mfma_f32_16x16x32_bf16 a[248:251], a[136:139], v[96:99], a[248:251]
    v_mfma_f32_16x16x32_bf16 a[252:255], a[140:143], v[96:99], a[252:255]
    s_waitcnt vmcnt(9)
    v_mfma_f32_16x16x32_bf16 a[240:243], a[144:147], v[100:103], a[240:243]
    buffer_load_dwordx4 v[44:47], v4, s[56:59], s76 offen offset:3072 sc1
    v_mfma_f32_16x16x32_bf16 a[244:247], a[148:151], v[100:103], a[244:247]
    v_mfma_f32_16x16x32_bf16 a[248:251], a[152:155], v[100:103], a[248:251]
    v_mfma_f32_16x16x32_bf16 a[252:255], a[156:159], v[100:103], a[252:255]
    s_waitcnt vmcnt(9)
    v_mfma_f32_16x16x32_bf16 a[240:243], a[160:163], v[104:107], a[240:243]
    s_add_u32 s42, s3, 3
    s_and_b32 s42, s42, 3
    s_add_u32 s42, s42, s40
    s_mul_i32 s42, s42, 114688
    s_add_u32 s76, s42, s36
    buffer_load_dwordx4 v[48:51], v4, s[56:59], s76 offen offset:0 sc1
    v_mfma_f32_16x16x32_bf16 a[244:247], a[164:167], v[104:107], a[244:247]
    v_mfma_f32_16x16x32_bf16 a[248:251], a[168:171], v[104:107], a[248:251]
    v_mfma_f32_16x16x32_bf16 a[252:255], a[172:175], v[104:107], a[252:255]
    s_waitcnt vmcnt(9)
    v_mfma_f32_16x16x32_bf16 a[240:243], a[176:179], v[108:111], a[240:243]
    buffer_load_dwordx4 v[52:55], v4, s[56:59], s76 offen offset:1024 sc1
    v_mfma_f32_16x16x32_bf16 a[244:247], a[180:183], v[108:111], a[244:247]
    v_mfma_f32_16x16x32_bf16 a[248:251], a[184:187], v[108:111], a[248:251]
    v_mfma_f32_16x16x32_bf16 a[252:255], a[188:191], v[108:111], a[252:255]
    s_waitcnt vmcnt(9)
    v_mfma_f32_16x16x32_bf16 a[240:243], a[192:195], v[16:19], a[240:243]
    buffer_load_dwordx4 v[56:59], v4, s[56:59], s76 offen offset:2048 sc1
    v_mfma_f32_16x16x32_bf16 a[244:247], a[196:199], v[16:19], a[244:247]
    v_mfma_f32_16x16x32_bf16 a[248:251], a[200:203], v[16:19], a[248:251]
    v_mfma_f32_16x16x32_bf16 a[252:255], a[204:207], v[16:19], a[252:255]
    s_waitcnt vmcnt(9)
    v_mfma_f32_16x16x32_bf16 a[240:243], a[208:211], v[20:23], a[240:243]
    buffer_load_dwordx4 v[60:63], v4, s[56:59], s76 offen offset:3072 sc1
    v_mfma_f32_16x16x32_bf16 a[244:247], a[212:215], v[20:23], a[244:247]
    v_mfma_f32_16x16x32_bf16 a[248:251], a[216:219], v[20:23], a[248:251]
    v_mfma_f32_16x16x32_bf16 a[252:255], a[220:223], v[20:23], a[252:255]
    s_waitcnt vmcnt(9)
    v_mfma_f32_16x16x32_bf16 a[240:243], a[0:3], v[24:27], a[240:243]
    s_add_u32 s76, s76, 4096
    buffer_load_dwordx4 v[64:67], v4, s[56:59], s76 offen offset:0 sc1
    v_mfma_f32_16x16x32_bf16 a[244:247], a[4:7], v[24:27], a[244:247]
    v_mfma_f32_16x16x32_bf16 a[248:251], a[8:11], v[24:27], a[248:251]
    v_mfma_f32_16x16x32_bf16 a[252:255], a[12:15], v[24:27], a[252:255]
    s_waitcnt vmcnt(9)
    v_mfma_f32_16x16x32_bf16 a[240:243], a[16:19], v[28:31], a[240:243]
    buffer_load_dwordx4 v[68:71], v4, s[56:59], s76 offen offset:1024 sc1
    v_mfma_f32_16x16x32_bf16 a[244:247], a[20:23], v[28:31], a[244:247]
    v_mfma_f32_16x16x32_bf16 a[248:251], a[24:27], v[28:31], a[248:251]
    v_mfma_f32_16x16x32_bf16 a[252:255], a[28:31], v[28:31], a[252:255]
    s_waitcnt vmcnt(9)
    v_mfma_f32_16x16x32_bf16 a[240:243], a[32:35], v[32:35], a[240:243]
    buffer_load_dwordx4 v[72:75], v4, s[56:59], s76 offen offset:2048 sc1
    v_mfma_f32_16x16x32_bf16 a[244:247], a[36:39], v[32:35], a[244:247]
    v_mfma_f32_16x16x32_bf16 a[248:251], a[40:43], v[32:35], a[248:251]
    v_mfma_f32_16x16x32_bf16 a[252:255], a[44:47], v[32:35], a[252:255]
    s_waitcnt vmcnt(9)
    v_mfma_f32_16x16x32_bf16 a[240:243], a[48:51], v[36:39], a[240:243]
    buffer_load_dwordx4 v[76:79], v4, s[56:59], s76 offen offset:3072 sc1
    v_mfma_f32_16x16x32_bf16 a[244:247], a[52:55], v[36:39], a[244:247]
    v_mfma_f32_16x16x32_bf16 a[248:251], a[56:59], v[36:39], a[248:251]
    v_mfma_f32_16x16x32_bf16 a[252:255], a[60:63], v[36:39], a[252:255]
    s_waitcnt vmcnt(9)
    v_mfma_f32_16x16x32_bf16 a[240:243], v[112:115], v[40:43], a[240:243]
    s_add_u32 s76, s42, s37
    buffer_load_dwordx4 v[80:83], v4, s[56:59], s76 offen offset:0 sc1
    v_mfma_f32_16x16x32_bf16 a[244:247], v[116:119], v[40:43], a[244:247]
    v_mfma_f32_16x16x32_bf16 a[248:251], v[120:123], v[40:43], a[248:251]
    v_mfma_f32_16x16x32_bf16 a[252:255], v[124:127], v[40:43], a[252:255]
    s_waitcnt vmcnt(9)
    v_mfma_f32_16x16x32_bf16 a[240:243], v[128:131], v[44:47], a[240:243]
    buffer_load_dwordx4 v[84:87], v4, s[56:59], s76 offen offset:1024 sc1
    v_mfma_f32_16x16x32_bf16 a[244:247], v[132:135], v[44:47], a[244:247]
    v_mfma_f32_16x16x32_bf16 a[248:251], v[136:139], v[44:47], a[248:251]
    v_mfma_f32_16x16x32_bf16 a[252:255], v[140:143], v[44:47], a[252:255]
    s_waitcnt vmcnt(9)
    v_mfma_f32_16x16x32_bf16 a[224:227], a[64:67], v[48:51], 0
    buffer_load_dwordx4 v[88:91], v4, s[56:59], s76 offen offset:2048 sc1
    buffer_load_dwordx4 v[92:95], v4, s[56:59], s76 offen offset:3072 sc1
    v_mfma_f32_16x16x32_bf16 a[228:231], a[68:71], v[48:51], 0
    v_mfma_f32_16x16x32_bf16 a[232:235], a[72:75], v[48:51], 0
    v_mfma_f32_16x16x32_bf16 a[236:239], a[76:79], v[48:51], 0
    s_waitcnt vmcnt(10)
    v_mfma_f32_16x16x32_bf16 a[224:227], a[80:83], v[52:55], a[224:227]
    s_add_u32 s76, s76, 4096
    buffer_load_dwordx4 v[96:99], v4, s[56:59], s76 offen offset:0 sc1
    buffer_load_dwordx4 v[100:103], v4, s[56:59], s76 offen offset:1024 sc1
    v_mfma_f32_16x16x32_bf16 a[228:231], a[84:87], v[52:55], a[228:231]
    v_mfma_f32_16x16x32_bf16 a[232:235], a[88:91], v[52:55], a[232:235]
    v_mfma_f32_16x16x32_bf16 a[236:239], a[92:95], v[52:55], a[236:239]
    s_waitcnt vmcnt(11)
    v_mfma_f32_16x16x32_bf16 a[224:227], a[96:99], v[56:59], a[224:227]
    buffer_load_dwordx4 v[104:107], v4, s[56:59], s76 offen offset:2048 sc1
    v_mfma_f32_16x16x32_bf16 a[228:231], a[100:103], v[56:59], a[228:231]
    ds_write_b128 v232, a[240:243] offset:4096

    v_mfma_f32_16x16x32_bf16 a[232:235], a[104:107], v[56:59], a[232:235]
    ds_write_b128 v232, a[244:247] offset:5120

    v_mfma_f32_16x16x32_bf16 a[236:239], a[108:111], v[56:59], a[236:239]
    ds_write_b128 v232, a[248:251] offset:6144

    s_waitcnt vmcnt(11)
    v_mfma_f32_16x16x32_bf16 a[224:227], a[112:115], v[60:63], a[224:227]
    buffer_load_dwordx4 v[108:111], v4, s[56:59], s76 offen offset:3072 sc1
    v_mfma_f32_16x16x32_bf16 a[228:231], a[116:119], v[60:63], a[228:231]
    ds_write_b128 v232, a[252:255] offset:7168

    v_mfma_f32_16x16x32_bf16 a[232:235], a[120:123], v[60:63], a[232:235]
    v_mfma_f32_16x16x32_bf16 a[236:239], a[124:127], v[60:63], a[236:239]
    s_waitcnt vmcnt(11)
    v_mfma_f32_16x16x32_bf16 a[224:227], a[128:131], v[64:67], a[224:227]
    s_add_u32 s42, s3, 4
    s_and_b32 s42, s42, 3
    s_add_u32 s42, s42, s40
    s_mul_i32 s42, s42, 114688
    s_add_u32 s76, s42, s36
    buffer_load_dwordx4 v[16:19], v4, s[56:59], s76 offen offset:0 sc1
    v_mfma_f32_16x16x32_bf16 a[228:231], a[132:135], v[64:67], a[228:231]
    v_mfma_f32_16x16x32_bf16 a[232:235], a[136:139], v[64:67], a[232:235]
    v_mfma_f32_16x16x32_bf16 a[236:239], a[140:143], v[64:67], a[236:239]
    s_waitcnt vmcnt(11)
    v_mfma_f32_16x16x32_bf16 a[224:227], a[144:147], v[68:71], a[224:227]
    buffer_load_dword v238, v237, s[56:59], s7 offen sc1
    v_mfma_f32_16x16x32_bf16 a[228:231], a[148:151], v[68:71], a[228:231]
    v_mfma_f32_16x16x32_bf16 a[232:235], a[152:155], v[68:71], a[232:235]
    v_mfma_f32_16x16x32_bf16 a[236:239], a[156:159], v[68:71], a[236:239]
    s_waitcnt vmcnt(11)
    v_mfma_f32_16x16x32_bf16 a[224:227], a[160:163], v[72:75], a[224:227]
    buffer_load_dwordx4 v[20:23], v4, s[56:59], s76 offen offset:1024 sc1
    v_mfma_f32_16x16x32_bf16 a[228:231], a[164:167], v[72:75], a[228:231]
    v_mfma_f32_16x16x32_bf16 a[232:235], a[168:171], v[72:75], a[232:235]
    v_mfma_f32_16x16x32_bf16 a[236:239], a[172:175], v[72:75], a[236:239]
    s_waitcnt vmcnt(11)
    v_mfma_f32_16x16x32_bf16 a[224:227], a[176:179], v[76:79], a[224:227]
    buffer_load_dwordx4 v[24:27], v4, s[56:59], s76 offen offset:2048 sc1
    v_mfma_f32_16x16x32_bf16 a[228:231], a[180:183], v[76:79], a[228:231]
    v_mfma_f32_16x16x32_bf16 a[232:235], a[184:187], v[76:79], a[232:235]
    v_mfma_f32_16x16x32_bf16 a[236:239], a[188:191], v[76:79], a[236:239]
    s_waitcnt vmcnt(11)
    v_mfma_f32_16x16x32_bf16 a[224:227], a[192:195], v[80:83], a[224:227]
    buffer_load_dwordx4 v[28:31], v4, s[56:59], s76 offen offset:3072 sc1
    v_mfma_f32_16x16x32_bf16 a[228:231], a[196:199], v[80:83], a[228:231]
    v_mfma_f32_16x16x32_bf16 a[232:235], a[200:203], v[80:83], a[232:235]
    v_mfma_f32_16x16x32_bf16 a[236:239], a[204:207], v[80:83], a[236:239]
    s_waitcnt vmcnt(11)
    v_mfma_f32_16x16x32_bf16 a[224:227], a[208:211], v[84:87], a[224:227]
    s_add_u32 s76, s76, 4096
    buffer_load_dwordx4 v[32:35], v4, s[56:59], s76 offen offset:0 sc1
    v_mfma_f32_16x16x32_bf16 a[228:231], a[212:215], v[84:87], a[228:231]
    v_mfma_f32_16x16x32_bf16 a[232:235], a[216:219], v[84:87], a[232:235]
    v_mfma_f32_16x16x32_bf16 a[236:239], a[220:223], v[84:87], a[236:239]
    s_waitcnt vmcnt(11)
    v_mfma_f32_16x16x32_bf16 a[224:227], a[0:3], v[88:91], a[224:227]
    buffer_load_dwordx4 v[36:39], v4, s[56:59], s76 offen offset:1024 sc1
    v_mfma_f32_16x16x32_bf16 a[228:231], a[4:7], v[88:91], a[228:231]
    v_mfma_f32_16x16x32_bf16 a[232:235], a[8:11], v[88:91], a[232:235]
    v_mfma_f32_16x16x32_bf16 a[236:239], a[12:15], v[88:91], a[236:239]
    s_waitcnt vmcnt(11)
    v_mfma_f32_16x16x32_bf16 a[224:227], a[16:19], v[92:95], a[224:227]
    buffer_load_dwordx4 v[40:43], v4, s[56:59], s76 offen offset:2048 sc1
    v_mfma_f32_16x16x32_bf16 a[228:231], a[20:23], v[92:95], a[228:231]
    v_mfma_f32_16x16x32_bf16 a[232:235], a[24:27], v[92:95], a[232:235]
    v_mfma_f32_16x16x32_bf16 a[236:239], a[28:31], v[92:95], a[236:239]
    s_waitcnt vmcnt(11)
    v_mfma_f32_16x16x32_bf16 a[224:227], a[32:35], v[96:99], a[224:227]
    buffer_load_dwordx4 v[44:47], v4, s[56:59], s76 offen offset:3072 sc1
    v_mfma_f32_16x16x32_bf16 a[228:231], a[36:39], v[96:99], a[228:231]
    v_mfma_f32_16x16x32_bf16 a[232:235], a[40:43], v[96:99], a[232:235]
    v_mfma_f32_16x16x32_bf16 a[236:239], a[44:47], v[96:99], a[236:239]
    s_waitcnt vmcnt(11)
    v_mfma_f32_16x16x32_bf16 a[224:227], a[48:51], v[100:103], a[224:227]
    s_add_u32 s76, s42, s37
    buffer_load_dwordx4 v[48:51], v4, s[56:59], s76 offen offset:0 sc1
    v_mfma_f32_16x16x32_bf16 a[228:231], a[52:55], v[100:103], a[228:231]
    v_mfma_f32_16x16x32_bf16 a[232:235], a[56:59], v[100:103], a[232:235]
    v_mfma_f32_16x16x32_bf16 a[236:239], a[60:63], v[100:103], a[236:239]
    s_waitcnt vmcnt(11)
    v_mfma_f32_16x16x32_bf16 a[224:227], v[112:115], v[104:107], a[224:227]
    buffer_load_dwordx4 v[52:55], v4, s[56:59], s76 offen offset:1024 sc1
    v_mfma_f32_16x16x32_bf16 a[228:231], v[116:119], v[104:107], a[228:231]
    v_mfma_f32_16x16x32_bf16 a[232:235], v[120:123], v[104:107], a[232:235]
    v_mfma_f32_16x16x32_bf16 a[236:239], v[124:127], v[104:107], a[236:239]
    s_waitcnt vmcnt(11)
    v_mfma_f32_16x16x32_bf16 a[224:227], v[128:131], v[108:111], a[224:227]
    buffer_load_dwordx4 v[56:59], v4, s[56:59], s76 offen offset:2048 sc1
    v_mfma_f32_16x16x32_bf16 a[228:231], v[132:135], v[108:111], a[228:231]
    v_mfma_f32_16x16x32_bf16 a[232:235], v[136:139], v[108:111], a[232:235]
    v_mfma_f32_16x16x32_bf16 a[236:239], v[140:143], v[108:111], a[236:239]
    s_waitcnt vmcnt(11)
    v_mfma_f32_16x16x32_bf16 v[240:243], a[64:67], v[16:19], 0
    buffer_load_dwordx4 v[60:63], v4, s[56:59], s76 offen offset:3072 sc1
    v_mfma_f32_16x16x32_bf16 v[244:247], a[68:71], v[16:19], 0
    v_mfma_f32_16x16x32_bf16 v[248:251], a[72:75], v[16:19], 0
    v_mfma_f32_16x16x32_bf16 v[252:255], a[76:79], v[16:19], 0
    s_waitcnt vmcnt(10)
    v_cmp_ne_u32 vcc, s69, v238
    s_mov_b32 s75, 0
    s_cbranch_vccz POLLX_4
POLL_3:
    s_sleep 8
    buffer_load_dword v238, v237, s[56:59], s7 offen sc1
    s_add_u32 s75, s75, 1
    s_waitcnt vmcnt(0)
    v_cmp_ne_u32 vcc, s69, v238
    s_cmp_gt_u32 s75, 0x40000
    s_cbranch_scc1 POLLX_4
    s_cbranch_vccnz POLL_3
POLLX_4:
    v_mfma_f32_16x16x32_bf16 v[240:243], a[80:83], v[20:23], v[240:243]
    s_add_u32 s76, s76, 4096
    buffer_load_dwordx4 v[64:67], v4, s[56:59], s76 offen offset:0 sc1
    buffer_load_dwordx4 v[68:71], v4, s[56:59], s76 offen offset:1024 sc1
    v_mfma_f32_16x16x32_bf16 v[244:247], a[84:87], v[20:23], v[244:247]
    v_mfma_f32_16x16x32_bf16 v[248:251], a[88:91], v[20:23], v[248:251]
    v_mfma_f32_16x16x32_bf16 v[252:255], a[92:95], v[20:23], v[252:255]
    s_waitcnt vmcnt(11)
    v_mfma_f32_16x16x32_bf16 v[240:243], a[96:99], v[24:27], v[240:243]
    buffer_load_dwordx4 v[72:75], v4, s[56:59], s76 offen offset:2048 sc1
    v_mfma_f32_16x16x32_bf16 v[244:247], a[100:103], v[24:27], v[244:247]
    ds_write_b128 v232, a[224:227] offset:8192

    v_mfma_f32_16x16x32_bf16 v[248:251], a[104:107], v[24:27], v[248:251]
    ds_write_b128 v232, a[228:231] offset:9216

    v_mfma_f32_16x16x32_bf16 v[252:255], a[108:111], v[24:27], v[252:255]
    ds_write_b128 v232, a[232:235] offset:10240

    s_waitcnt vmcnt(11)
    v_mfma_f32_16x16x32_bf16 v[240:243], a[112:115], v[28:31], v[240:243]
    buffer_load_dwordx4 v[76:79], v4, s[56:59], s76 offen offset:3072 sc1
    v_mfma_f32_16x16x32_bf16 v[244:247], a[116:119], v[28:31], v[244:247]
    ds_write_b128 v232, a[236:239] offset:11264

    v_mfma_f32_16x16x32_bf16 v[248:251], a[120:123], v[28:31], v[248:251]
    v_mfma_f32_16x16x32_bf16 v[252:255], a[124:127], v[28:31], v[252:255]
    s_waitcnt vmcnt(11)
    v_mfma_f32_16x16x32_bf16 v[240:243], a[128:131], v[32:35], v[240:243]
    s_add_u32 s42, s3, 1
    s_and_b32 s42, s42, 3
    s_add_u32 s42, s42, s41
    s_mul_i32 s42, s42, 114688
    s_add_u32 s76, s42, s36
    buffer_load_dwordx4 v[80:83], v4, s[56:59], s76 offen offset:0 sc1
    v_mfma_f32_16x16x32_bf16 v[244:247], a[132:135], v[32:35], v[244:247]
    s_waitcnt lgkmcnt(0)
    s_barrier
    v_mfma_f32_16x16x32_bf16 v[248:251], a[136:139], v[32:35], v[248:251]
    ds_read_b128 v[144:147], v233 offset:0
    ds_read_b128 v[148:151], v233 offset:1024
    v_mfma_f32_16x16x32_bf16 v[252:255], a[140:143], v[32:35], v[252:255]
    ds_read_b128 v[152:155], v233 offset:2048
    ds_read_b128 v[156:159], v233 offset:3072
    s_waitcnt vmcnt(11)
    v_mfma_f32_16x16x32_bf16 v[240:243], a[144:147], v[36:39], v[240:243]
    buffer_load_dwordx4 v[84:87], v4, s[56:59], s76 offen offset:1024 sc1
    v_mfma_f32_16x16x32_bf16 v[244:247], a[148:151], v[36:39], v[244:247]
    ds_read_b128 v[160:163], v234 offset:0
    ds_read_b128 v[164:167], v234 offset:1024
    v_mfma_f32_16x16x32_bf16 v[248:251], a[152:155], v[36:39], v[248:251]
    ds_read_b128 v[168:171], v234 offset:2048
    ds_read_b128 v[172:175], v234 offset:3072
    v_mfma_f32_16x16x32_bf16 v[252:255], a[156:159], v[36:39], v[252:255]
    ds_read_b128 v[176:179], v235 offset:0
    ds_read_b128 v[180:183], v235 offset:1024
    s_waitcnt vmcnt(11)
    v_mfma_f32_16x16x32_bf16 v[240:243], a[160:163], v[40:43], v[240:243]
    buffer_load_dwordx4 v[88:91], v4, s[56:59], s76 offen offset:2048 sc1
    v_mfma_f32_16x16x32_bf16 v[244:247], a[164:167], v[40:43], v[244:247]
    ds_read_b128 v[184:187], v235 offset:2048
    ds_read_b128 v[188:191], v235 offset:3072
    v_mfma_f32_16x16x32_bf16 v[248:251], a[168:171], v[40:43], v[248:251]
    s_waitcnt lgkmcnt(4)
    v_add_f32 v144, v144, v160
    v_mfma_f32_16x16x32_bf16 v[252:255], a[172:175], v[40:43], v[252:255]
    v_add_f32 v145, v145, v161
    v_add_f32 v146, v146, v162
    s_waitcnt vmcnt(11)
    v_mfma_f32_16x16x32_bf16 v[240:243], a[176:179], v[44:47], v[240:243]
    buffer_load_dwordx4 v[92:95], v4, s[56:59], s76 offen offset:3072 sc1
    v_mfma_f32_16x16x32_bf16 v[244:247], a[180:183], v[44:47], v[244:247]
    v_add_f32 v147, v147, v163
    v_add_f32 v148, v148, v164
    v_mfma_f32_16x16x32_bf16 v[248:251], a[184:187], v[44:47], v[248:251]
    v_add_f32 v149, v149, v165
    v_add_f32 v150, v150, v166
    v_mfma_f32_16x16x32_bf16 v[252:255], a[188:191], v[44:47], v[252:255]
    v_add_f32 v151, v151, v167
    v_add_f32 v152, v152, v168
    s_waitcnt vmcnt(11)
    v_mfma_f32_16x16x32_bf16 v[240:243], a[192:195], v[48:51], v[240:243]
    s_add_u32 s76, s76, 4096
    buffer_load_dwordx4 v[96:99], v4, s[56:59], s76 offen offset:0 sc1
    v_mfma_f32_16x16x32_bf16 v[244:247], a[196:199], v[48:51], v[244:247]
    v_add_f32 v153, v153, v169
    v_add_f32 v154, v154, v170
    v_mfma_f32_16x16x32_bf16 v[248:251], a[200:203], v[48:51], v[248:251]
    v_add_f32 v155, v155, v171
    v_add_f32 v156, v156, v172
    v_mfma_f32_16x16x32_bf16 v[252:255], a[204:207], v[48:51], v[252:255]
    v_add_f32 v157, v157, v173
    v_add_f32 v158, v158, v174
    s_waitcnt vmcnt(11)
    v_mfma_f32_16x16x32_bf16 v[240:243], a[208:211], v[52:55], v[240:243]
    buffer_load_dwordx4 v[100:103], v4, s[56:59], s76 offen offset:1024 sc1
    v_mfma_f32_16x16x32_bf16 v[244:247], a[212:215], v[52:55], v[244:247]
    v_add_f32 v159, v159, v175
    s_waitcnt lgkmcnt(0)
    v_mfma_f32_16x16x32_bf16 v[248:251], a[216:219], v[52:55], v[248:251]
    v_add_f32 v144, v144, v176
    v_add_f32 v145, v145, v177
    v_mfma_f32_16x16x32_bf16 v[252:255], a[220:223], v[52:55], v[252:255]
    v_add_f32 v146, v146, v178
    v_add_f32 v147, v147, v179
    s_waitcnt vmcnt(11)
    v_mfma_f32_16x16x32_bf16 v[240:243], a[0:3], v[56:59], v[240:243]
    buffer_load_dwordx4 v[104:107], v4, s[56:59], s76 offen offset:2048 sc1
    v_mfma_f32_16x16x32_bf16 v[244:247], a[4:7], v[56:59], v[244:247]
    v_add_f32 v148, v148, v180
    v_add_f32 v149, v149, v181
    v_mfma_f32_16x16x32_bf16 v[248:251], a[8:11], v[56:59], v[248:251]
    v_add_f32 v150, v150, v182
    v_add_f32 v151, v151, v183
    v_mfma_f32_16x16x32_bf16 v[252:255], a[12:15], v[56:59], v[252:255]
    v_add_f32 v152, v152, v184
    v_add_f32 v153, v153, v185
    s_waitcnt vmcnt(11)
    v_mfma_f32_16x16x32_bf16 v[240:243], a[16:19], v[60:63], v[240:243]
    buffer_load_dwordx4 v[108:111], v4, s[56:59], s76 offen offset:3072 sc1
    v_mfma_f32_16x16x32_bf16 v[244:247], a[20:23], v[60:63], v[244:247]
    v_add_f32 v154, v154, v186
    v_add_f32 v155, v155, v187
    v_mfma_f32_16x16x32_bf16 v[248:251], a[24:27], v[60:63], v[248:251]
    v_add_f32 v156, v156, v188
    v_add_f32 v157, v157, v189
    v_mfma_f32_16x16x32_bf16 v[252:255], a[28:31], v[60:63], v[252:255]
    v_add_f32 v158, v158, v190
    v_add_f32 v159, v159, v191
    s_waitcnt vmcnt(11)
    v_mfma_f32_16x16x32_bf16 v[240:243], a[32:35], v[64:67], v[240:243]
    s_add_u32 s76, s42, s37
    buffer_load_dwordx4 v[16:19], v4, s[56:59], s76 offen offset:0 sc1
    v_mfma_f32_16x16x32_bf16 v[244:247], a[36:39], v[64:67], v[244:247]
    v_mfma_f32_16x16x32_bf16 v[248:251], a[40:43], v[64:67], v[248:251]
    v_mfma_f32_16x16x32_bf16 v[252:255], a[44:47], v[64:67], v[252:255]
    s_waitcnt vmcnt(11)
    v_mfma_f32_16x16x32_bf16 v[240:243], a[48:51], v[68:71], v[240:243]
    buffer_load_dwordx4 v[20:23], v4, s[56:59], s76 offen offset:1024 sc1
    v_mfma_f32_16x16x32_bf16 v[244:247], a[52:55], v[68:71], v[244:247]
    v_mfma_f32_16x16x32_bf16 v[248:251], a[56:59], v[68:71], v[248:251]
    v_mfma_f32_16x16x32_bf16 v[252:255], a[60:63], v[68:71], v[252:255]
    s_waitcnt vmcnt(11)
    v_mfma_f32_16x16x32_bf16 v[240:243], v[112:115], v[72:75], v[240:243]
    buffer_load_dwordx4 v[24:27], v4, s[56:59], s76 offen offset:2048 sc1
    v_mfma_f32_16x16x32_bf16 v[244:247], v[116:119], v[72:75], v[244:247]
    v_mfma_f32_16x16x32_bf16 v[248:251], v[120:123], v[72:75], v[248:251]
    v_mfma_f32_16x16x32_bf16 v[252:255], v[124:127], v[72:75], v[252:255]
    s_waitcnt vmcnt(11)
    v_mfma_f32_16x16x32_bf16 v[240:243], v[128:131], v[76:79], v[240:243]
    buffer_load_dwordx4 v[28:31], v4, s[56:59], s76 offen offset:3072 sc1
    v_mfma_f32_16x16x32_bf16 v[244:247], v[132:135], v[76:79], v[244:247]
    v_mfma_f32_16x16x32_bf16 v[248:251], v[136:139], v[76:79], v[248:251]
    v_mfma_f32_16x16x32_bf16 v[252:255], v[140:143], v[76:79], v[252:255]
    s_waitcnt vmcnt(11)
    v_mfma_f32_16x16x32_bf16 a[224:227], a[64:67], v[80:83], 0
    s_add_u32 s76, s76, 4096
    buffer_load_dwordx4 v[32:35], v4, s[56:59], s76 offen offset:0 sc1
    v_mfma_f32_16x16x32_bf16 a[228:231], a[68:71], v[80:83], 0
    v_mfma_f32_16x16x32_bf16 a[232:235], a[72:75], v[80:83], 0
    v_mfma_f32_16x16x32_bf16 a[236:239], a[76:79], v[80:83], 0
    s_waitcnt vmcnt(11)
    v_mfma_f32_16x16x32_bf16 a[224:227], a[80:83], v[84:87], a[224:227]
    buffer_load_dwordx4 v[36:39], v4, s[56:59], s76 offen offset:1024 sc1
    v_mfma_f32_16x16x32_bf16 a[228:231], a[84:87], v[84:87], a[228:231]
    v_mfma_f32_16x16x32_bf16 a[232:235], a[88:91], v[84:87], a[232:235]
    v_mfma_f32_16x16x32_bf16 a[236:239], a[92:95], v[84:87], a[236:239]
    s_waitcnt vmcnt(11)
    v_mfma_f32_16x16x32_bf16 a[224:227], a[96:99], v[88:91], a[224:227]
    buffer_load_dwordx4 v[40:43], v4, s[56:59], s76 offen offset:2048 sc1
    v_mfma_f32_16x16x32_bf16 a[228:231], a[100:103], v[88:91], a[228:231]
    v_add_f32 v144, v144, v240
    v_add_f32 v145, v145, v241
    v_mfma_f32_16x16x32_bf16 a[232:235], a[104:107], v[88:91], a[232:235]
    v_add_f32 v146, v146, v242
    v_add_f32 v147, v147, v243
    v_mfma_f32_16x16x32_bf16 a[236:239], a[108:111], v[88:91], a[236:239]
    v_add_f32 v148, v148, v244
    v_add_f32 v149, v149, v245
    s_waitcnt vmcnt(11)
    v_mfma_f32_16x16x32_bf16 a[224:227], a[112:115], v[92:95], a[224:227]
    buffer_load_dwordx4 v[44:47], v4, s[56:59], s76 offen offset:3072 sc1
    v_mfma_f32_16x16x32_bf16 a[228:231], a[116:119], v[92:95], a[228:231]
    v_add_f32 v150, v150, v246
    v_add_f32 v151, v151, v247
    v_mfma_f32_16x16x32_bf16 a[232:235], a[120:123], v[92:95], a[232:235]
    v_add_f32 v152, v152, v248
    v_add_f32 v153, v153, v249
    v_mfma_f32_16x16x32_bf16 a[236:239], a[124:127], v[92:95], a[236:239]
    v_add_f32 v154, v154, v250
    v_add_f32 v155, v155, v251
    s_waitcnt vmcnt(11)
    v_mfma_f32_16x16x32_bf16 a[224:227], a[128:131], v[96:99], a[224:227]
    s_add_u32 s42, s3, 2
    s_and_b32 s42, s42, 3
    s_add_u32 s42, s42, s41
    s_mul_i32 s42, s42, 114688
    s_add_u32 s76, s42, s36
    buffer_load_dwordx4 v[48:51], v4, s[56:59], s76 offen offset:0 sc1
    v_mfma_f32_16x16x32_bf16 a[228:231], a[132:135], v[96:99], a[228:231]
    v_add_f32 v156, v156, v252
    v_add_f32 v157, v157, v253
    v_mfma_f32_16x16x32_bf16 a[232:235], a[136:139], v[96:99], a[232:235]
    v_add_f32 v158, v158, v254
    v_add_f32 v159, v159, v255
    v_mfma_f32_16x16x32_bf16 a[236:239], a[140:143], v[96:99], a[236:239]
    v_bfi_b32 v144, v228, v224, v144
    v_bfi_b32 v145, v228, v225, v145
    s_waitcnt vmcnt(11)
    v_mfma_f32_16x16x32_bf16 a[224:227], a[144:147], v[100:103], a[224:227]
    buffer_load_dwordx4 v[52:55], v4, s[56:59], s76 offen offset:1024 sc1
    v_mfma_f32_16x16x32_bf16 a[228:231], a[148:151], v[100:103], a[228:231]
    v_bfi_b32 v146, v228, v226, v146
    v_bfi_b32 v147, v228, v227, v147
    v_mfma_f32_16x16x32_bf16 a[232:235], a[152:155], v[100:103], a[232:235]
    v_bfi_b32 v148, v228, v224, v148
    v_bfi_b32 v149, v228, v225, v149
    v_mfma_f32_16x16x32_bf16 a[236:239], a[156:159], v[100:103], a[236:239]
    v_bfi_b32 v150, v228, v226, v150
    v_bfi_b32 v151, v228, v227, v151
    s_waitcnt vmcnt(11)
    v_mfma_f32_16x16x32_bf16 a[224:227], a[160:163], v[104:107], a[224:227]
    buffer_load_dwordx4 v[56:59], v4, s[56:59], s76 offen offset:2048 sc1
    v_mfma_f32_16x16x32_bf16 a[228:231], a[164:167], v[104:107], a[228:231]
    v_bfi_b32 v152, v228, v224, v152
    v_bfi_b32 v153, v228, v225, v153
    v_mfma_f32_16x16x32_bf16 a[232:235], a[168:171], v[104:107], a[232:235]
    v_bfi_b32 v154, v228, v226, v154
    v_bfi_b32 v155, v228, v227, v155
    v_mfma_f32_16x16x32_bf16 a[236:239], a[172:175], v[104:107], a[236:239]
    v_bfi_b32 v156, v228, v224, v156
    v_bfi_b32 v157, v228, v225, v157
    s_waitcnt vmcnt(11)
    v_mfma_f32_16x16x32_bf16 a[224:227], a[176:179], v[108:111], a[224:227]
    buffer_load_dwordx4 v[60:63], v4, s[56:59], s76 offen offset:3072 sc1
    v_mfma_f32_16x16x32_bf16 a[228:231], a[180:183], v[108:111], a[228:231]
    v_bfi_b32 v158, v228, v226, v158
    v_bfi_b32 v159, v228, v227, v159
    v_mfma_f32_16x16x32_bf16 a[232:235], a[184:187], v[108:111], a[232:235]
    v_mfma_f32_16x16x32_bf16 a[236:239], a[188:191], v[108:111], a[236:239]
    buffer_store_dwordx4 v[144:147], v4, s[56:59], s94 offen offset:0 sc1
    buffer_store_dwordx4 v[148:151], v4, s[56:59], s94 offen offset:1024 sc1
    buffer_store_dwordx4 v[152:155], v4, s[56:59], s94 offen offset:2048 sc1
    buffer_store_dwordx4 v[156:159], v4, s[56:59], s94 offen offset:3072 sc1
    s_waitcnt vmcnt(15)
    v_mfma_f32_16x16x32_bf16 a[224:227], a[192:195], v[16:19], a[224:227]
    s_add_u32 s76, s76, 4096
    buffer_load_dwordx4 v[64:67], v4, s[56:59], s76 offen offset:0 sc1
    v_mfma_f32_16x16x32_bf16 a[228:231], a[196:199], v[16:19], a[228:231]
    v_mfma_f32_16x16x32_bf16 a[232:235], a[200:203], v[16:19], a[232:235]
    v_mfma_f32_16x16x32_bf16 a[236:239], a[204:207], v[16:19], a[236:239]
    s_waitcnt vmcnt(15)
    v_mfma_f32_16x16x32_bf16 a[224:227], a[208:211], v[20:23], a[224:227]
    buffer_load_dwordx4 v[68:71], v4, s[56:59], s76 offen offset:1024 sc1
    v_mfma_f32_16x16x32_bf16 a[228:231], a[212:215], v[20:23], a[228:231]
    v_mfma_f32_16x16x32_bf16 a[232:235], a[216:219], v[20:23], a[232:235]
    v_mfma_f32_16x16x32_bf16 a[236:239], a[220:223], v[20:23], a[236:239]
    s_waitcnt vmcnt(15)
    v_mfma_f32_16x16x32_bf16 a[224:227], a[0:3], v[24:27], a[224:227]
    buffer_load_dwordx4 v[72:75], v4, s[56:59], s76 offen offset:2048 sc1
    v_mfma_f32_16x16x32_bf16 a[228:231], a[4:7], v[24:27], a[228:231]
    v_mfma_f32_16x16x32_bf16 a[232:235], a[8:11], v[24:27], a[232:235]
    v_mfma_f32_16x16x32_bf16 a[236:239], a[12:15], v[24:27], a[236:239]
    s_waitcnt vmcnt(15)
    v_mfma_f32_16x16x32_bf16 a[224:227], a[16:19], v[28:31], a[224:227]
    buffer_load_dwordx4 v[76:79], v4, s[56:59], s76 offen offset:3072 sc1
    v_mfma_f32_16x16x32_bf16 a[228:231], a[20:23], v[28:31], a[228:231]
    v_mfma_f32_16x16x32_bf16 a[232:235], a[24:27], v[28:31], a[232:235]
    v_mfma_f32_16x16x32_bf16 a[236:239], a[28:31], v[28:31], a[236:239]
    s_waitcnt vmcnt(15)
    v_mfma_f32_16x16x32_bf16 a[224:227], a[32:35], v[32:35], a[224:227]
    s_add_u32 s76, s42, s37
    buffer_load_dwordx4 v[80:83], v4, s[56:59], s76 offen offset:0 sc1
    v_mfma_f32_16x16x32_bf16 a[228:231], a[36:39], v[32:35], a[228:231]
    v_mfma_f32_16x16x32_bf16 a[232:235], a[40:43], v[32:35], a[232:235]
    v_mfma_f32_16x16x32_bf16 a[236:239], a[44:47], v[32:35], a[236:239]
    s_waitcnt vmcnt(15)
    v_mfma_f32_16x16x32_bf16 a[224:227], a[48:51], v[36:39], a[224:227]
    buffer_load_dwordx4 v[84:87], v4, s[56:59], s76 offen offset:1024 sc1
    v_mfma_f32_16x16x32_bf16 a[228:231], a[52:55], v[36:39], a[228:231]
    v_mfma_f32_16x16x32_bf16 a[232:235], a[56:59], v[36:39], a[232:235]
    v_mfma_f32_16x16x32_bf16 a[236:239], a[60:63], v[36:39], a[236:239]
    s_waitcnt vmcnt(15)
    v_mfma_f32_16x16x32_bf16 a[224:227], v[112:115], v[40:43], a[224:227]
    buffer_load_dwordx4 v[88:91], v4, s[56:59], s76 offen offset:2048 sc1
    v_mfma_f32_16x16x32_bf16 a[228:231], v[116:119], v[40:43], a[228:231]
    v_mfma_f32_16x16x32_bf16 a[232:235], v[120:123], v[40:43], a[232:235]
    v_mfma_f32_16x16x32_bf16 a[236:239], v[124:127], v[40:43], a[236:239]
    s_waitcnt vmcnt(15)
    v_mfma_f32_16x16x32_bf16 a[224:227], v[128:131], v[44:47], a[224:227]
    buffer_load_dwordx4 v[92:95], v4, s[56:59], s76 offen offset:3072 sc1
    v_mfma_f32_16x16x32_bf16 a[228:231], v[132:135], v[44:47], a[228:231]
    v_mfma_f32_16x16x32_bf16 a[232:235], v[136:139], v[44:47], a[232:235]
    v_mfma_f32_16x16x32_bf16 a[236:239], v[140:143], v[44:47], a[236:239]
    s_waitcnt vmcnt(15)
    v_mfma_f32_16x16x32_bf16 a[240:243], a[64:67], v[48:51], 0
    s_add_u32 s76, s76, 4096
    buffer_load_dwordx4 v[96:99], v4, s[56:59], s76 offen offset:0 sc1
    v_mfma_f32_16x16x32_bf16 a[244:247], a[68:71], v[48:51], 0
    v_mfma_f32_16x16x32_bf16 a[248:251], a[72:75], v[48:51], 0
    v_mfma_f32_16x16x32_bf16 a[252:255], a[76:79], v[48:51], 0
    s_waitcnt vmcnt(15)
    v_mfma_f32_16x16x32_bf16 a[240:243], a[80:83], v[52:55], a[240:243]
    buffer_load_dwordx4 v[100:103], v4, s[56:59], s76 offen offset:1024 sc1
    v_mfma_f32_16x16x32_bf16 a[244:247], a[84:87], v[52:55], a[244:247]
    v_mfma_f32_16x16x32_bf16 a[248:251], a[88:91], v[52:55], a[248:251]
    v_mfma_f32_16x16x32_bf16 a[252:255], a[92:95], v[52:55], a[252:255]
    s_waitcnt vmcnt(15)
    v_mfma_f32_16x16x32_bf16 a[240:243], a[96:99], v[56:59], a[240:243]
    buffer_load_dwordx4 v[104:107], v4, s[56:59], s76 offen offset:2048 sc1
    v_mfma_f32_16x16x32_bf16 a[244:247], a[100:103], v[56:59], a[244:247]
    ds_write_b128 v232, a[224:227] offset:20480

    v_mfma_f32_16x16x32_bf16 a[248:251], a[104:107], v[56:59], a[248:251]
    ds_write_b128 v232, a[228:231] offset:21504

    v_mfma_f32_16x16x32_bf16 a[252:255], a[108:111], v[56:59], a[252:255]
    ds_write_b128 v232, a[232:235] offset:22528

    s_waitcnt vmcnt(15)
    v_mfma_f32_16x16x32_bf16 a[240:243], a[112:115], v[60:63], a[240:243]
    buffer_load_dwordx4 v[108:111], v4, s[56:59], s76 offen offset:3072 sc1
    v_mfma_f32_16x16x32_bf16 a[244:247], a[116:119], v[60:63], a[244:247]
    ds_write_b128 v232, a[236:239] offset:23552

    v_mfma_f32_16x16x32_bf16 a[248:251], a[120:123], v[60:63], a[248:251]
    v_mfma_f32_16x16x32_bf16 a[252:255], a[124:127], v[60:63], a[252:255]
    s_waitcnt vmcnt(11)
    v_mfma_f32_16x16x32_bf16 a[240:243], a[128:131], v[64:67], a[240:243]
    s_add_u32 s42, s3, 3
    s_and_b32 s42, s42, 3
    s_add_u32 s42, s42, s41
    s_mul_i32 s42, s42, 114688
    s_add_u32 s76, s42, s36
    buffer_load_dwordx4 v[16:19], v4, s[56:59], s76 offen offset:0 sc1
    buffer_load_dwordx4 v[20:23], v4, s[56:59], s76 offen offset:1024 sc1
    v_mfma_f32_16x16x32_bf16 a[244:247], a[132:135], v[64:67], a[244:247]
    v_mfma_f32_16x16x32_bf16 a[248:251], a[136:139], v[64:67], a[248:251]
    v_mfma_f32_16x16x32_bf16 a[252:255], a[140:143], v[64:67], a[252:255]
    s_waitcnt vmcnt(12)
    v_mfma_f32_16x16x32_bf16 a[240:243], a[144:147], v[68:71], a[240:243]
    v_mfma_f32_16x16x32_bf16 a[244:247], a[148:151], v[68:71], a[244:247]
    v_mfma_f32_16x16x32_bf16 a[248:251], a[152:155], v[68:71], a[248:251]
    v_mfma_f32_16x16x32_bf16 a[252:255], a[156:159], v[68:71], a[252:255]
    s_waitcnt vmcnt(11)
    v_mfma_f32_16x16x32_bf16 a[240:243], a[160:163], v[72:75], a[240:243]
    v_mfma_f32_16x16x32_bf16 a[244:247], a[164:167], v[72:75], a[244:247]
    v_mfma_f32_16x16x32_bf16 a[248:251], a[168:171], v[72:75], a[248:251]
    v_mfma_f32_16x16x32_bf16 a[252:255], a[172:175], v[72:75], a[252:255]
    s_waitcnt vmcnt(10)
    v_mfma_f32_16x16x32_bf16 a[240:243], a[176:179], v[76:79], a[240:243]
    v_mfma_f32_16x16x32_bf16 a[244:247], a[180:183], v[76:79], a[244:247]
    v_mfma_f32_16x16x32_bf16 a[248:251], a[184:187], v[76:79], a[248:251]
    v_mfma_f32_16x16x32_bf16 a[252:255], a[188:191], v[76:79], a[252:255]
    s_waitcnt vmcnt(9)
    v_mfma_f32_16x16x32_bf16 a[240:243], a[192:195], v[80:83], a[240:243]
    buffer_load_dwordx4 v[24:27], v4, s[56:59], s76 offen offset:2048 sc1
    v_mfma_f32_16x16x32_bf16 a[244:247], a[196:199], v[80:83], a[244:247]
    v_mfma_f32_16x16x32_bf16 a[248:251], a[200:203], v[80:83], a[248:251]
    v_mfma_f32_16x16x32_bf16 a[252:255], a[204:207], v[80:83], a[252:255]
    s_waitcnt vmcnt(9)
    v_mfma_f32_16x16x32_bf16 a[240:243], a[208:211], v[84:87], a[240:243]
    buffer_load_dwordx4 v[28:31], v4, s[56:59], s76 offen offset:3072 sc1
    v_mfma_f32_16x16x32_bf16 a[244:247], a[212:215], v[84:87], a[244:247]
    v_mfma_f32_16x16x32_bf16 a[248:251], a[216:219], v[84:87], a[248:251]
    v_mfma_f32_16x16x32_bf16 a[252:255], a[220:223], v[84:87], a[252:255]
    s_waitcnt vmcnt(9)
    v_mfma_f32_16x16x32_bf16 a[240:243], a[0:3], v[88:91], a[240:243]
    s_add_u32 s76, s76, 4096
    buffer_load_dwordx4 v[32:35], v4, s[56:59], s76 offen offset:0 sc1
    v_mfma_f32_16x16x32_bf16 a[244:247], a[4:7], v[88:91], a[244:247]
    v_mfma_f32_16x16x32_bf16 a[248:251], a[8:11], v[88:91], a[248:251]
    v_mfma_f32_16x16x32_bf16 a[252:255], a[12:15], v[88:91], a[252:255]
    s_waitcnt vmcnt(9)
    v_mfma_f32_16x16x32_bf16 a[240:243], a[16:19], v[92:95], a[240:243]
    buffer_load_dwordx4 v[36:39], v4, s[56:59], s76 offen offset:1024 sc1
    v_mfma_f32_16x16x32_bf16 a[244:247], a[20:23], v[92:95], a[244:247]
    v_mfma_f32_16x16x32_bf16 a[248:251], a[24:27], v[92:95], a[248:251]
    v_mfma_f32_16x16x32_bf16 a[252:255], a[28:31], v[92:95], a[252:255]
    s_waitcnt vmcnt(9)
    v_mfma_f32_16x16x32_bf16 a[240:243], a[32:35], v[96:99], a[240:243]
    buffer_load_dwordx4 v[40:43], v4, s[56:59], s76 offen offset:2048 sc1
    v_mfma_f32_16x16x32_bf16 a[244:247], a[36:39], v[96:99], a[244:247]
    v_mfma_f32_16x16x32_bf16 a[248:251], a[40:43], v[96:99], a[248:251]
    v_mfma_f32_16x16x32_bf16 a[252:255], a[44:47], v[96:99], a[252:255]
    s_waitcnt vmcnt(9)
    v_mfma_f32_16x16x32_bf16 a[240:243], a[48:51], v[100:103], a[240:243]
    buffer_load_dwordx4 v[44:47], v4, s[56:59], s76 offen offset:3072 sc1
    v_mfma_f32_16x16x32_bf16 a[244:247], a[52:55], v[100:103], a[244:247]
    v_mfma_f32_16x16x32_bf16 a[248:251], a[56:59], v[100:103], a[248:251]
    v_mfma_f32_16x16x32_bf16 a[252:255], a[60:63], v[100:103], a[252:255]
    s_waitcnt vmcnt(9)
    v_mfma_f32_16x16x32_bf16 a[240:243], v[112:115], v[104:107], a[240:243]
    s_add_u32 s76, s42, s37
    buffer_load_dwordx4 v[48:51], v4, s[56:59], s76 offen offset:0 sc1
    v_mfma_f32_16x16x32_bf16 a[244:247], v[116:119], v[104:107], a[244:247]
    v_mfma_f32_16x16x32_bf16 a[248:251], v[120:123], v[104:107], a[248:251]
    v_mfma_f32_16x16x32_bf16 a[252:255], v[124:127], v[104:107], a[252:255]
    s_waitcnt vmcnt(9)
    v_mfma_f32_16x16x32_bf16 a[240:243], v[128:131], v[108:111], a[240:243]
    buffer_load_dwordx4 v[52:55], v4, s[56:59], s76 offen offset:1024 sc1
    v_mfma_f32_16x16x32_bf16 a[244:247], v[132:135], v[108:111], a[244:247]
    v_mfma_f32_16x16x32_bf16 a[248:251], v[136:139], v[108:111], a[248:251]
    v_mfma_f32_16x16x32_bf16 a[252:255], v[140:143], v[108:111], a[252:255]
    s_waitcnt vmcnt(9)
    v_mfma_f32_16x16x32_bf16 a[224:227], a[64:67], v[16:19], 0
    buffer_load_dwordx4 v[56:59], v4, s[56:59], s76 offen offset:2048 sc1
    v_mfma_f32_16x16x32_bf16 a[228:231], a[68:71], v[16:19], 0
    v_mfma_f32_16x16x32_bf16 a[232:235], a[72:75], v[16:19], 0
    v_mfma_f32_16x16x32_bf16 a[236:239], a[76:79], v[16:19], 0
    s_waitcnt vmcnt(9)
    v_mfma_f32_16x16x32_bf16 a[224:227], a[80:83], v[20:23], a[224:227]
    buffer_load_dwordx4 v[60:63], v4, s[56:59], s76 offen offset:3072 sc1
    v_mfma_f32_16x16x32_bf16 a[228:231], a[84:87], v[20:23], a[228:231]
    v_mfma_f32_16x16x32_bf16 a[232:235], a[88:91], v[20:23], a[232:235]
    v_mfma_f32_16x16x32_bf16 a[236:239], a[92:95], v[20:23], a[236:239]
    s_waitcnt vmcnt(9)
    v_mfma_f32_16x16x32_bf16 a[224:227], a[96:99], v[24:27], a[224:227]
    s_add_u32 s76, s76, 4096
    buffer_load_dwordx4 v[64:67], v4, s[56:59], s76 offen offset:0 sc1
    v_mfma_f32_16x16x32_bf16 a[228:231], a[100:103], v[24:27], a[228:231]
    ds_write_b128 v232, a[240:243] offset:24576

    v_mfma_f32_16x16x32_bf16 a[232:235], a[104:107], v[24:27], a[232:235]
    ds_write_b128 v232, a[244:247] offset:25600

    v_mfma_f32_16x16x32_bf16 a[236:239], a[108:111], v[24:27], a[236:239]
    ds_write_b128 v232, a[248:251] offset:26624

    s_waitcnt vmcnt(9)
    v_mfma_f32_16x16x32_bf16 a[224:227], a[112:115], v[28:31], a[224:227]
    buffer_load_dwordx4 v[68:71], v4, s[56:59], s76 offen offset:1024 sc1
    v_mfma_f32_16x16x32_bf16 a[228:231], a[116:119], v[28:31], a[228:231]
    ds_write_b128 v232, a[252:255] offset:27648

    v_mfma_f32_16x16x32_bf16 a[232:235], a[120:123], v[28:31], a[232:235]
    v_mfma_f32_16x16x32_bf16 a[236:239], a[124:127], v[28:31], a[236:239]
    s_waitcnt vmcnt(9)
    v_mfma_f32_16x16x32_bf16 a[224:227], a[128:131], v[32:35], a[224:227]
    buffer_load_dwordx4 v[72:75], v4, s[56:59], s76 offen offset:2048 sc1
    v_mfma_f32_16x16x32_bf16 a[228:231], a[132:135], v[32:35], a[228:231]
    v_mfma_f32_16x16x32_bf16 a[232:235], a[136:139], v[32:35], a[232:235]
    v_mfma_f32_16x16x32_bf16 a[236:239], a[140:143], v[32:35], a[236:239]
    s_waitcnt vmcnt(9)
    v_mfma_f32_16x16x32_bf16 a[224:227], a[144:147], v[36:39], a[224:227]
    buffer_load_dwordx4 v[76:79], v4, s[56:59], s76 offen offset:3072 sc1
    v_mfma_f32_16x16x32_bf16 a[228:231], a[148:151], v[36:39], a[228:231]
    v_mfma_f32_16x16x32_bf16 a[232:235], a[152:155], v[36:39], a[232:235]
    v_mfma_f32_16x16x32_bf16 a[236:239], a[156:159], v[36:39], a[236:239]
    s_waitcnt vmcnt(9)
    v_mfma_f32_16x16x32_bf16 a[224:227], a[160:163], v[40:43], a[224:227]
    s_add_u32 s42, s3, 4
    s_and_b32 s42, s42, 3
    s_add_u32 s42, s42, s41
    s_mul_i32 s42, s42, 114688
    s_add_u32 s76, s42, s36
    buffer_load_dwordx4 v[80:83], v4, s[56:59], s76 offen offset:0 sc1
    v_mfma_f32_16x16x32_bf16 a[228:231], a[164:167], v[40:43], a[228:231]
    v_mfma_f32_16x16x32_bf16 a[232:235], a[168:171], v[40:43], a[232:235]
    v_mfma_f32_16x16x32_bf16 a[236:239], a[172:175], v[40:43], a[236:239]
    s_waitcnt vmcnt(9)
    v_mfma_f32_16x16x32_bf16 a[224:227], a[176:179], v[44:47], a[224:227]
    buffer_load_dwordx4 v[84:87], v4, s[56:59], s76 offen offset:1024 sc1
    v_mfma_f32_16x16x32_bf16 a[228:231], a[180:183], v[44:47], a[228:231]
    v_mfma_f32_16x16x32_bf16 a[232:235], a[184:187], v[44:47], a[232:235]
    v_mfma_f32_16x16x32_bf16 a[236:239], a[188:191], v[44:47], a[236:239]
    s_waitcnt vmcnt(9)
    v_mfma_f32_16x16x32_bf16 a[224:227], a[192:195], v[48:51], a[224:227]
    buffer_load_dwordx4 v[88:91], v4, s[56:59], s76 offen offset:2048 sc1
    v_mfma_f32_16x16x32_bf16 a[228:231], a[196:199], v[48:51], a[228:231]
    v_mfma_f32_16x16x32_bf16 a[232:235], a[200:203], v[48:51], a[232:235]
    v_mfma_f32_16x16x32_bf16 a[236:239], a[204:207], v[48:51], a[236:239]
    s_waitcnt vmcnt(9)
    v_mfma_f32_16x16x32_bf16 a[224:227], a[208:211], v[52:55], a[224:227]
    buffer_load_dwordx4 v[92:95], v4, s[56:59], s76 offen offset:3072 sc1
    v_mfma_f32_16x16x32_bf16 a[228:231], a[212:215], v[52:55], a[228:231]
    v_mfma_f32_16x16x32_bf16 a[232:235], a[216:219], v[52:55], a[232:235]
    v_mfma_f32_16x16x32_bf16 a[236:239], a[220:223], v[52:55], a[236:239]
    s_waitcnt vmcnt(9)
    v_mfma_f32_16x16x32_bf16 a[224:227], a[0:3], v[56:59], a[224:227]
    s_add_u32 s76, s76, 4096
    buffer_load_dwordx4 v[96:99], v4, s[56:59], s76 offen offset:0 sc1
    v_mfma_f32_16x16x32_bf16 a[228:231], a[4:7], v[56:59], a[228:231]
    v_mfma_f32_16x16x32_bf16 a[232:235], a[8:11], v[56:59], a[232:235]
    v_mfma_f32_16x16x32_bf16 a[236:239], a[12:15], v[56:59], a[236:239]
    s_waitcnt vmcnt(9)
    v_mfma_f32_16x16x32_bf16 a[224:227], a[16:19], v[60:63], a[224:227]
    buffer_load_dwordx4 v[100:103], v4, s[56:59], s76 offen offset:1024 sc1
    v_mfma_f32_16x16x32_bf16 a[228:231], a[20:23], v[60:63], a[228:231]
    v_mfma_f32_16x16x32_bf16 a[232:235], a[24:27], v[60:63], a[232:235]
    v_mfma_f32_16x16x32_bf16 a[236:239], a[28:31], v[60:63], a[236:239]
    s_waitcnt vmcnt(9)
    v_mfma_f32_16x16x32_bf16 a[224:227], a[32:35], v[64:67], a[224:227]
    buffer_load_dwordx4 v[208:211], v4, s[56:59], s95 offen offset:0 sc1
    v_mfma_f32_16x16x32_bf16 a[228:231], a[36:39], v[64:67], a[228:231]
    v_mfma_f32_16x16x32_bf16 a[232:235], a[40:43], v[64:67], a[232:235]
    v_mfma_f32_16x16x32_bf16 a[236:239], a[44:47], v[64:67], a[236:239]
    s_waitcnt vmcnt(9)
    v_mfma_f32_16x16x32_bf16 a[224:227], a[48:51], v[68:71], a[224:227]
    buffer_load_dwordx4 v[212:215], v4, s[56:59], s95 offen offset:1024 sc1
    v_mfma_f32_16x16x32_bf16 a[228:231], a[52:55], v[68:71], a[228:231]
    v_mfma_f32_16x16x32_bf16 a[232:235], a[56:59], v[68:71], a[232:235]
    v_mfma_f32_16x16x32_bf16 a[236:239], a[60:63], v[68:71], a[236:239]
    s_waitcnt vmcnt(9)
    v_mfma_f32_16x16x32_bf16 a[224:227], v[112:115], v[72:75], a[224:227]
    buffer_load_dwordx4 v[216:219], v4, s[56:59], s95 offen offset:2048 sc1
    v_mfma_f32_16x16x32_bf16 a[228:231], v[116:119], v[72:75], a[228:231]
    v_mfma_f32_16x16x32_bf16 a[232:235], v[120:123], v[72:75], a[232:235]
    v_mfma_f32_16x16x32_bf16 a[236:239], v[124:127], v[72:75], a[236:239]
    s_waitcnt vmcnt(9)
    v_mfma_f32_16x16x32_bf16 a[224:227], v[128:131], v[76:79], a[224:227]
    buffer_load_dwordx4 v[220:223], v4, s[56:59], s95 offen offset:3072 sc1
    v_mfma_f32_16x16x32_bf16 a[228:231], v[132:135], v[76:79], a[228:231]
    v_mfma_f32_16x16x32_bf16 a[232:235], v[136:139], v[76:79], a[232:235]
    v_mfma_f32_16x16x32_bf16 a[236:239], v[140:143], v[76:79], a[236:239]
    s_waitcnt vmcnt(9)
    v_mfma_f32_16x16x32_bf16 v[240:243], a[64:67], v[80:83], 0
    buffer_load_dwordx4 v[104:107], v4, s[56:59], s76 offen offset:2048 sc1
    v_mfma_f32_16x16x32_bf16 v[244:247], a[68:71], v[80:83], 0
    v_mfma_f32_16x16x32_bf16 v[248:251], a[72:75], v[80:83], 0
    v_mfma_f32_16x16x32_bf16 v[252:255], a[76:79], v[80:83], 0
    s_waitcnt vmcnt(9)
    v_mfma_f32_16x16x32_bf16 v[240:243], a[80:83], v[84:87], v[240:243]
    buffer_load_dwordx4 v[108:111], v4, s[56:59], s76 offen offset:3072 sc1
    v_mfma_f32_16x16x32_bf16 v[244:247], a[84:87], v[84:87], v[244:247]
    v_mfma_f32_16x16x32_bf16 v[248:251], a[88:91], v[84:87], v[248:251]
    v_mfma_f32_16x16x32_bf16 v[252:255], a[92:95], v[84:87], v[252:255]
    s_waitcnt vmcnt(9)
    v_mfma_f32_16x16x32_bf16 v[240:243], a[96:99], v[88:91], v[240:243]
    s_add_u32 s76, s42, s37
    buffer_load_dwordx4 v[16:19], v4, s[56:59], s76 offen offset:0 sc1
    v_mfma_f32_16x16x32_bf16 v[244:247], a[100:103], v[88:91], v[244:247]
    ds_write_b128 v232, a[224:227] offset:28672

    v_mfma_f32_16x16x32_bf16 v[248:251], a[104:107], v[88:91], v[248:251]
    ds_write_b128 v232, a[228:231] offset:29696

    v_mfma_f32_16x16x32_bf16 v[252:255], a[108:111], v[88:91], v[252:255]
    ds_write_b128 v232, a[232:235] offset:30720

    s_waitcnt vmcnt(9)
    v_mfma_f32_16x16x32_bf16 v[240:243], a[112:115], v[92:95], v[240:243]
    buffer_load_dwordx4 v[20:23], v4, s[56:59], s76 offen offset:1024 sc1
    v_mfma_f32_16x16x32_bf16 v[244:247], a[116:119], v[92:95], v[244:247]
    ds_write_b128 v232, a[236:239] offset:31744

    v_mfma_f32_16x16x32_bf16 v[248:251], a[120:123], v[92:95], v[248:251]
    v_mfma_f32_16x16x32_bf16 v[252:255], a[124:127], v[92:95], v[252:255]
    s_waitcnt vmcnt(9)
    v_mfma_f32_16x16x32_bf16 v[240:243], a[128:131], v[96:99], v[240:243]
    buffer_load_dwordx4 v[24:27], v4, s[56:59], s76 offen offset:2048 sc1
    v_mfma_f32_16x16x32_bf16 v[244:247], a[132:135], v[96:99], v[244:247]
    s_waitcnt lgkmcnt(0)
    s_barrier
    v_mfma_f32_16x16x32_bf16 v[248:251], a[136:139], v[96:99], v[248:251]
    ds_read_b128 v[144:147], v233 offset:20480
    ds_read_b128 v[148:151], v233 offset:21504
    v_mfma_f32_16x16x32_bf16 v[252:255], a[140:143], v[96:99], v[252:255]
    ds_read_b128 v[152:155], v233 offset:22528
    ds_read_b128 v[156:159], v233 offset:23552
    s_waitcnt vmcnt(9)
    v_mfma_f32_16x16x32_bf16 v[240:243], a[144:147], v[100:103], v[240:243]
    buffer_load_dwordx4 v[28:31], v4, s[56:59], s76 offen offset:3072 sc1
    v_mfma_f32_16x16x32_bf16 v[244:247], a[148:151], v[100:103], v[244:247]
    ds_read_b128 v[160:163], v234 offset:20480
    ds_read_b128 v[164:167], v234 offset:21504
    v_mfma_f32_16x16x32_bf16 v[248:251], a[152:155], v[100:103], v[248:251]
    ds_read_b128 v[168:171], v234 offset:22528
    ds_read_b128 v[172:175], v234 offset:23552
    v_mfma_f32_16x16x32_bf16 v[252:255], a[156:159], v[100:103], v[252:255]
    ds_read_b128 v[176:179], v235 offset:20480
    ds_read_b128 v[180:183], v235 offset:21504
    s_waitcnt vmcnt(5)
    v_mfma_f32_16x16x32_bf16 v[240:243], a[160:163], v[104:107], v[240:243]
    s_add_u32 s76, s76, 4096
    buffer_load_dwordx4 v[32:35], v4, s[56:59], s76 offen offset:0 sc1
    buffer_load_dwordx4 v[36:39], v4, s[56:59], s76 offen offset:1024 sc1
    buffer_load_dwordx4 v[40:43], v4, s[56:59], s76 offen offset:2048 sc1
    buffer_load_dwordx4 v[44:47], v4, s[56:59], s76 offen offset:3072 sc1
    v_mfma_f32_16x16x32_bf16 v[244:247], a[164:167], v[104:107], v[244:247]
    ds_read_b128 v[184:187], v235 offset:22528
    ds_read_b128 v[188:191], v235 offset:23552
    v_mfma_f32_16x16x32_bf16 v[248:251], a[168:171], v[104:107], v[248:251]
    s_waitcnt lgkmcnt(4)
    v_add_f32 v144, v144, v160
    v_mfma_f32_16x16x32_bf16 v[252:255], a[172:175], v[104:107], v[252:255]
    v_add_f32 v145, v145, v161
    v_add_f32 v146, v146, v162
    s_waitcnt vmcnt(8)
    v_mfma_f32_16x16x32_bf16 v[240:243], a[176:179], v[108:111], v[240:243]
    v_mfma_f32_16x16x32_bf16 v[244:247], a[180:183], v[108:111], v[244:247]
    v_add_f32 v147, v147, v163
    v_add_f32 v148, v148, v164
    v_mfma_f32_16x16x32_bf16 v[248:251], a[184:187], v[108:111], v[248:251]
    v_add_f32 v149, v149, v165
    v_add_f32 v150, v150, v166
    v_mfma_f32_16x16x32_bf16 v[252:255], a[188:191], v[108:111], v[252:255]
    v_add_f32 v151, v151, v167
    v_add_f32 v152, v152, v168
    s_waitcnt vmcnt(7)
    v_mfma_f32_16x16x32_bf16 v[240:243], a[192:195], v[16:19], v[240:243]
    v_mfma_f32_16x16x32_bf16 v[244:247], a[196:199], v[16:19], v[244:247]
    v_add_f32 v153, v153, v169
    v_add_f32 v154, v154, v170
    v_mfma_f32_16x16x32_bf16 v[248:251], a[200:203], v[16:19], v[248:251]
    v_add_f32 v155, v155, v171
    v_add_f32 v156, v156, v172
    v_mfma_f32_16x16x32_bf16 v[252:255], a[204:207], v[16:19], v[252:255]
    v_add_f32 v157, v157, v173
    v_add_f32 v158, v158, v174
    s_waitcnt vmcnt(6)
    v_mfma_f32_16x16x32_bf16 v[240:243], a[208:211], v[20:23], v[240:243]
    v_mfma_f32_16x16x32_bf16 v[244:247], a[212:215], v[20:23], v[244:247]
    v_add_f32 v159, v159, v175
    s_waitcnt lgkmcnt(0)
    v_mfma_f32_16x16x32_bf16 v[248:251], a[216:219], v[20:23], v[248:251]
    v_add_f32 v144, v144, v176
    v_add_f32 v145, v145, v177
    v_mfma_f32_16x16x32_bf16 v[252:255], a[220:223], v[20:23], v[252:255]
    v_add_f32 v146, v146, v178
    v_add_f32 v147, v147, v179
    s_waitcnt vmcnt(5)
    v_mfma_f32_16x16x32_bf16 v[240:243], a[0:3], v[24:27], v[240:243]
    v_mfma_f32_16x16x32_bf16 v[244:247], a[4:7], v[24:27], v[244:247]
    v_add_f32 v148, v148, v180
    v_add_f32 v149, v149, v181
    v_mfma_f32_16x16x32_bf16 v[248:251], a[8:11], v[24:27], v[248:251]
    v_add_f32 v150, v150, v182
    v_add_f32 v151, v151, v183
    v_mfma_f32_16x16x32_bf16 v[252:255], a[12:15], v[24:27], v[252:255]
    v_add_f32 v152, v152, v184
    v_add_f32 v153, v153, v185
    s_waitcnt vmcnt(4)
    v_mfma_f32_16x16x32_bf16 v[240:243], a[16:19], v[28:31], v[240:243]
    v_mfma_f32_16x16x32_bf16 v[244:247], a[20:23], v[28:31], v[244:247]
    v_add_f32 v154, v154, v186
    v_add_f32 v155, v155, v187
    v_mfma_f32_16x16x32_bf16 v[248:251], a[24:27], v[28:31], v[248:251]
    v_add_f32 v156, v156, v188
    v_add_f32 v157, v157, v189
    v_mfma_f32_16x16x32_bf16 v[252:255], a[28:31], v[28:31], v[252:255]
    v_add_f32 v158, v158, v190
    v_add_f32 v159, v159, v191
    s_waitcnt vmcnt(3)
    v_mfma_f32_16x16x32_bf16 v[240:243], a[32:35], v[32:35], v[240:243]
    v_mfma_f32_16x16x32_bf16 v[244:247], a[36:39], v[32:35], v[244:247]
    v_perm_b32 v192, v209, v208, v229
    v_perm_b32 v193, v211, v210, v230
    v_mfma_f32_16x16x32_bf16 v[248:251], a[40:43], v[32:35], v[248:251]
    v_or_b32 v192, v192, v193
    v_xor_b32 v194, s43, v192
    v_mfma_f32_16x16x32_bf16 v[252:255], a[44:47], v[32:35], v[252:255]
    v_perm_b32 v192, v213, v212, v229
    v_perm_b32 v193, v215, v214, v230
    s_waitcnt vmcnt(2)
    v_mfma_f32_16x16x32_bf16 v[240:243], a[48:51], v[36:39], v[240:243]
    v_mfma_f32_16x16x32_bf16 v[244:247], a[52:55], v[36:39], v[244:247]
    v_or_b32 v192, v192, v193
    v_xor_b32 v195, s43, v192
    v_mfma_f32_16x16x32_bf16 v[248:251], a[56:59], v[36:39], v[248:251]
    v_perm_b32 v192, v217, v216, v229
    v_perm_b32 v193, v219, v218, v230
    v_mfma_f32_16x16x32_bf16 v[252:255], a[60:63], v[36:39], v[252:255]
    v_or_b32 v192, v192, v193
    v_xor_b32 v196, s43, v192
    s_waitcnt vmcnt(1)
    v_mfma_f32_16x16x32_bf16 v[240:243], v[112:115], v[40:43], v[240:243]
    v_mfma_f32_16x16x32_bf16 v[244:247], v[116:119], v[40:43], v[244:247]
    v_perm_b32 v192, v221, v220, v229
    v_perm_b32 v193, v223, v222, v230
    v_mfma_f32_16x16x32_bf16 v[248:251], v[120:123], v[40:43], v[248:251]
    v_or_b32 v192, v192, v193
    v_xor_b32 v197, s43, v192
    v_mfma_f32_16x16x32_bf16 v[252:255], v[124:127], v[40:43], v[252:255]
    v_or3_b32 v192, v194, v195, v196
    v_or_b32 v192, v192, v197
    s_waitcnt vmcnt(0)
    v_mfma_f32_16x16x32_bf16 v[240:243], v[128:131], v[44:47], v[240:243]
    v_mfma_f32_16x16x32_bf16 v[244:247], v[132:135], v[44:47], v[244:247]
    v_cmp_ne_u32 vcc, 0, v192
    v_add_f32 v208, v208, v144
    v_mfma_f32_16x16x32_bf16 v[248:251], v[136:139], v[44:47], v[248:251]
    v_add_f32 v209, v209, v145
    v_add_f32 v210, v210, v146
    v_mfma_f32_16x16x32_bf16 v[252:255], v[140:143], v[44:47], v[252:255]
    v_add_f32 v211, v211, v147
    v_add_f32 v212, v212, v148
    v_add_f32 v213, v213, v149
    v_add_f32 v214, v214, v150
    v_add_f32 v215, v215, v151
    v_add_f32 v216, v216, v152
    v_add_f32 v217, v217, v153
    v_add_f32 v218, v218, v154
    v_add_f32 v219, v219, v155
    v_add_f32 v220, v220, v156
    v_add_f32 v221, v221, v157
    v_add_f32 v222, v222, v158
    v_add_f32 v223, v223, v159
    s_mov_b32 s75, 0
    s_nop 2
    s_cbranch_vccz RETRYX_6
RETRY_5:
    buffer_load_dwordx4 v[208:211], v4, s[56:59], s95 offen offset:0 sc1
    buffer_load_dwordx4 v[212:215], v4, s[56:59], s95 offen offset:1024 sc1
    buffer_load_dwordx4 v[216:219], v4, s[56:59], s95 offen offset:2048 sc1
    buffer_load_dwordx4 v[220:223], v4, s[56:59], s95 offen offset:3072 sc1
    s_add_u32 s75, s75, 1
    s_waitcnt vmcnt(0)
    v_perm_b32 v192, v209, v208, v229
    v_perm_b32 v193, v211, v210, v230
    v_or_b32 v192, v192, v193
    v_xor_b32 v194, s43, v192
    v_perm_b32 v192, v213, v212, v229
    v_perm_b32 v193, v215, v214, v230
    v_or_b32 v192, v192, v193
    v_xor_b32 v195, s43, v192
    v_perm_b32 v192, v217, v216, v229
    v_perm_b32 v193, v219, v218, v230
    v_or_b32 v192, v192, v193
    v_xor_b32 v196, s43, v192
    v_perm_b32 v192, v221, v220, v229
    v_perm_b32 v193, v223, v222, v230
    v_or_b32 v192, v192, v193
    v_xor_b32 v197, s43, v192
    v_or3_b32 v192, v194, v195, v196
    v_or_b32 v192, v192, v197
    v_cmp_ne_u32 vcc, 0, v192
    v_pk_add_f32 v[208:209], v[208:209], v[144:145]
    v_pk_add_f32 v[210:211], v[210:211], v[146:147]
    v_pk_add_f32 v[212:213], v[212:213], v[148:149]
    v_pk_add_f32 v[214:215], v[214:215], v[150:151]
    v_pk_add_f32 v[216:217], v[216:217], v[152:153]
    v_pk_add_f32 v[218:219], v[218:219], v[154:155]
    v_pk_add_f32 v[220:221], v[220:221], v[156:157]
    v_pk_add_f32 v[222:223], v[222:223], v[158:159]
    s_cmp_gt_u32 s75, 0x40000
    s_cbranch_scc1 RETRYX_6
    s_cbranch_vccnz RETRY_5
RETRYX_6:
    s_nop 1
    v_pk_add_f32 v[240:241], v[240:241], v[208:209]
    v_pk_add_f32 v[242:243], v[242:243], v[210:211]
    v_pk_add_f32 v[244:245], v[244:245], v[212:213]
    v_pk_add_f32 v[246:247], v[246:247], v[214:215]
    v_pk_add_f32 v[248:249], v[248:249], v[216:217]
    v_pk_add_f32 v[250:251], v[250:251], v[218:219]
    v_pk_add_f32 v[252:253], v[252:253], v[220:221]
    v_pk_add_f32 v[254:255], v[254:255], v[222:223]
    v_cvt_pk_bf16_f32 v192, v240, v241
    v_cvt_pk_bf16_f32 v193, v242, v243
    v_cvt_pk_bf16_f32 v194, v244, v245
    v_cvt_pk_bf16_f32 v195, v246, v247
    v_cvt_pk_bf16_f32 v196, v248, v249
    v_cvt_pk_bf16_f32 v197, v250, v251
    v_cvt_pk_bf16_f32 v198, v252, v253
    v_cvt_pk_bf16_f32 v199, v254, v255
    s_nop 1
    v_permlane16_swap_b32 v192, v194
    v_permlane16_swap_b32 v193, v195
    v_permlane16_swap_b32 v196, v198
    v_permlane16_swap_b32 v197, v199
    buffer_store_dwordx4 v[192:195], v5, s[52:55], s96 offen offset:0 sc1
    buffer_store_dwordx4 v[196:199], v5, s[52:55], s96 offen offset:64 sc1
    s_or_b32 s70, s60, s62
    s_or_b32 s70, s70, s4
    s_cmp_lg_u32 s70, 0
    s_cbranch_scc1 FINISH
    s_add_u32 s70, s5, 1
    v_mov_b32 v9, s70
    s_lshl_b32 s70, s61, 7
    s_add_u32 s70, s70, 0x308000
    s_mov_b64 exec, 1
    buffer_store_dword v9, v0, s[56:59], s70 offen sc1
    s_mov_b64 exec, -1
    s_branch FINISH
ROLE_B:
    s_cmp_lt_u32 s62, 14
    s_cbranch_scc1 WORKER_B
    s_waitcnt lgkmcnt(0)
    s_mov_b32 s48, s18
    s_and_b32 s49, s19, 0xffff
    s_mov_b32 s50, 0x1880000
    s_mov_b32 s51, 0x20000
    s_mov_b32 s32, s10
    s_and_b32 s33, s11, 0xffff
    s_mov_b32 s34, 0xe00000
    s_mov_b32 s35, 0x20000
    s_mul_i32 s70, s60, 7
    s_sub_u32 s71, 1, s70
    s_and_b32 s71, s71, 3
    s_lshl_b32 s72, s61, 2
    s_add_u32 s72, s72, s71
    s_cmp_lt_u32 s72, 7
    s_cselect_b32 s71, s72, s71
    s_add_u32 s70, s70, s71
    s_lshl_b32 s70, s70, 8
    s_add_u32 s70, s70, 688128
    s_mul_i32 s71, s4, 3670016
    s_add_u32 s70, s70, s71
    s_mov_b32 s73, 688128
    v_lshrrev_b32 v5, 4, v1
    v_mul_u32_u24 v5, 14336, v5
    v_lshl_add_u32 v5, v3, 4, v5
    s_add_u32 s71, s70, 1089536
    buffer_load_dwordx4 v[16:19], v5, s[32:35], s71 offen
    s_add_u32 s71, s70, 2924544
    buffer_load_dwordx4 v[20:23], v5, s[32:35], s71 offen
    s_add_u32 s71, s70, 1032192
    buffer_load_dwordx4 v[24:27], v5, s[32:35], s71 offen
    s_add_u32 s71, s70, 2867200
    buffer_load_dwordx4 v[28:31], v5, s[32:35], s71 offen
    s_add_u32 s71, s70, 974848
    buffer_load_dwordx4 v[32:35], v5, s[32:35], s71 offen
    s_add_u32 s71, s70, 2809856
    buffer_load_dwordx4 v[36:39], v5, s[32:35], s71 offen
    s_add_u32 s71, s70, 917504
    buffer_load_dwordx4 v[40:43], v5, s[32:35], s71 offen
    s_add_u32 s71, s70, 2752512
    buffer_load_dwordx4 v[44:47], v5, s[32:35], s71 offen
    s_add_u32 s71, s70, 860160
    buffer_load_dwordx4 v[48:51], v5, s[32:35], s71 offen
    s_add_u32 s71, s70, 2695168
    buffer_load_dwordx4 v[52:55], v5, s[32:35], s71 offen
    s_add_u32 s71, s70, 802816
    buffer_load_dwordx4 v[56:59], v5, s[32:35], s71 offen
    s_add_u32 s71, s70, 2637824
    buffer_load_dwordx4 v[60:63], v5, s[32:35], s71 offen
    s_add_u32 s71, s70, 745472
    buffer_load_dwordx4 v[64:67], v5, s[32:35], s71 offen
    s_add_u32 s71, s70, 2580480
    buffer_load_dwordx4 v[68:71], v5, s[32:35], s71 offen
    s_add_u32 s71, s70, 688128
    buffer_load_dwordx4 v[72:75], v5, s[32:35], s71 offen
    s_add_u32 s71, s70, 2523136
    buffer_load_dwordx4 v[76:79], v5, s[32:35], s71 offen
    s_add_u32 s71, s70, 630784
    buffer_load_dwordx4 v[80:83], v5, s[32:35], s71 offen
    s_add_u32 s71, s70, 2465792
    buffer_load_dwordx4 v[84:87], v5, s[32:35], s71 offen
    s_add_u32 s71, s70, 573440
    buffer_load_dwordx4 v[88:91], v5, s[32:35], s71 offen
    s_add_u32 s71, s70, 2408448
    buffer_load_dwordx4 v[92:95], v5, s[32:35], s71 offen
    s_add_u32 s71, s70, 516096
    buffer_load_dwordx4 v[96:99], v5, s[32:35], s71 offen
    s_add_u32 s71, s70, 2351104
    buffer_load_dwordx4 v[100:103], v5, s[32:35], s71 offen
    s_add_u32 s71, s70, 458752
    buffer_load_dwordx4 v[104:107], v5, s[32:35], s71 offen
    s_add_u32 s71, s70, 2293760
    buffer_load_dwordx4 v[108:111], v5, s[32:35], s71 offen
    s_add_u32 s71, s70, 401408
    buffer_load_dwordx4 v[112:115], v5, s[32:35], s71 offen
    s_add_u32 s71, s70, 2236416
    buffer_load_dwordx4 v[116:119], v5, s[32:35], s71 offen
    s_add_u32 s71, s70, 344064
    buffer_load_dwordx4 v[120:123], v5, s[32:35], s71 offen
    s_add_u32 s71, s70, 2179072
    buffer_load_dwordx4 v[124:127], v5, s[32:35], s71 offen
    s_add_u32 s71, s70, 286720
    buffer_load_dwordx4 v[128:131], v5, s[32:35], s71 offen
    s_add_u32 s71, s70, 2121728
    buffer_load_dwordx4 v[132:135], v5, s[32:35], s71 offen
    s_add_u32 s71, s70, 229376
    buffer_load_dwordx4 v[136:139], v5, s[32:35], s71 offen
    s_add_u32 s71, s70, 2064384
    buffer_load_dwordx4 v[140:143], v5, s[32:35], s71 offen
    s_add_u32 s71, s70, 172032
    buffer_load_dwordx4 v[144:147], v5, s[32:35], s71 offen
    s_add_u32 s71, s70, 2007040
    buffer_load_dwordx4 v[148:151], v5, s[32:35], s71 offen
    s_add_u32 s71, s70, 114688
    buffer_load_dwordx4 v[152:155], v5, s[32:35], s71 offen
    s_add_u32 s71, s70, 1949696
    buffer_load_dwordx4 v[156:159], v5, s[32:35], s71 offen
    s_add_u32 s71, s70, 57344
    buffer_load_dwordx4 v[160:163], v5, s[32:35], s71 offen
    s_add_u32 s71, s70, 1892352
    buffer_load_dwordx4 v[164:167], v5, s[32:35], s71 offen
    s_add_u32 s71, s70, 0
    buffer_load_dwordx4 v[168:171], v5, s[32:35], s71 offen
    s_add_u32 s71, s70, 1835008
    buffer_load_dwordx4 v[172:175], v5, s[32:35], s71 offen
    s_lshr_b32 s70, s60, 1
    s_mul_i32 s70, s70, 14
    s_sub_u32 s71, 3, s70
    s_and_b32 s71, s71, 7
    s_lshl_b32 s72, s61, 3
    s_add_u32 s72, s72, s71
    s_cmp_lt_u32 s72, 14
    s_cselect_b32 s71, s72, s71
    s_add_u32 s70, s70, s71
    s_lshl_b32 s70, s70, 7
    s_xor_b32 s76, s70, 128
    s_mul_i32 s71, s4, 12
    s_mul_i32 s72, s4, 16
    s_add_u32 s72, s72, 48
    s_bitcmp1_b32 s60, 0
    s_cselect_b32 s71, s72, s71
    s_mul_i32 s71, s71, 229376
    s_add_u32 s70, s70, s71
    s_bitcmp1_b32 s60, 0
    s_cselect_b32 s71, 3, 0
    s_cselect_b32 s72, 4, 3
    s_cselect_b32 s73, 0xfff20000, 0
    s_mul_i32 s71, s71, 458752
    s_add_u32 s70, s70, s71
    v_lshrrev_b32 v5, 3, v1
    v_mul_u32_u24 v5, 7168, v5
    v_and_b32 v6, 7, v1
    v_lshl_add_u32 v5, v6, 4, v5
    s_mov_b32 s75, s72
HV15:
    buffer_load_dwordx4 v[16:19], v5, s[48:51], s70 offen
    s_add_u32 s70, s70, 57344
    buffer_load_dwordx4 v[20:23], v5, s[48:51], s70 offen
    s_add_u32 s70, s70, 57344
    buffer_load_dwordx4 v[24:27], v5, s[48:51], s70 offen
    s_add_u32 s70, s70, 57344
    buffer_load_dwordx4 v[28:31], v5, s[48:51], s70 offen
    s_add_u32 s70, s70, 57344
    buffer_load_dwordx4 v[32:35], v5, s[48:51], s70 offen
    s_add_u32 s70, s70, 57344
    buffer_load_dwordx4 v[36:39], v5, s[48:51], s70 offen
    s_add_u32 s70, s70, 57344
    buffer_load_dwordx4 v[40:43], v5, s[48:51], s70 offen
    s_add_u32 s70, s70, 57344
    buffer_load_dwordx4 v[44:47], v5, s[48:51], s70 offen
    s_add_u32 s70, s70, 57344
    s_add_u32 s70, s70, s73
    s_sub_u32 s75, s75, 1
    s_cmp_lg_u32 s75, 0
    s_cbranch_scc1 HV15
    s_bitcmp1_b32 s60, 0
    s_cbranch_scc0 HV15X
    s_mul_i32 s71, s4, 2752512
    s_add_u32 s76, s76, s71
    s_add_u32 s76, s76, 16056320
    s_mov_b32 s73, 0
    v_lshrrev_b32 v5, 3, v1
    v_mul_u32_u24 v5, 7168, v5
    v_and_b32 v6, 7, v1
    v_lshl_add_u32 v5, v6, 4, v5
    s_mov_b32 s75, 3
HV15B:
    buffer_load_dwordx4 v[16:19], v5, s[48:51], s76 offen
    s_add_u32 s76, s76, 57344
    buffer_load_dwordx4 v[20:23], v5, s[48:51], s76 offen
    s_add_u32 s76, s76, 57344
    buffer_load_dwordx4 v[24:27], v5, s[48:51], s76 offen
    s_add_u32 s76, s76, 57344
    buffer_load_dwordx4 v[28:31], v5, s[48:51], s76 offen
    s_add_u32 s76, s76, 57344
    buffer_load_dwordx4 v[32:35], v5, s[48:51], s76 offen
    s_add_u32 s76, s76, 57344
    buffer_load_dwordx4 v[36:39], v5, s[48:51], s76 offen
    s_add_u32 s76, s76, 57344
    buffer_load_dwordx4 v[40:43], v5, s[48:51], s76 offen
    s_add_u32 s76, s76, 57344
    buffer_load_dwordx4 v[44:47], v5, s[48:51], s76 offen
    s_add_u32 s76, s76, 57344
    s_add_u32 s76, s76, s73
    s_sub_u32 s75, s75, 1
    s_cmp_lg_u32 s75, 0
    s_cbranch_scc1 HV15B
HV15X:
    s_waitcnt vmcnt(0)
    s_branch FINISH
WORKER_B:
    s_lshl_b32 s65, s61, 1
    s_lshr_b32 s70, s62, 1
    s_mul_i32 s66, s60, 7
    s_add_u32 s66, s66, s70
    v_mul_u32_u24 v8, 57344, v2
    v_lshl_add_u32 v8, v3, 4, v8
    s_lshl_b32 s70, s66, 8
    v_add_u32 v8, s70, v8
    v_mul_u32_u24 v9, 7168, v2
    v_lshl_add_u32 v9, v3, 3, v9
    s_mul_i32 s70, s4, 28672
    s_lshl_b32 s71, s66, 7
    s_add_u32 s70, s70, s71
    v_add_u32 v9, s70, v9
    s_lshl_b32 s71, s61, 1
    s_xor_b32 s82, s71, 0
    s_lshl_b32 s70, s4, 2
    s_add_u32 s70, s70, s82
    s_mul_i32 s78, s70, 917504
    s_xor_b32 s83, s71, 1
    s_lshl_b32 s70, s4, 2
    s_add_u32 s70, s70, s83
    s_mul_i32 s79, s70, 917504
    s_xor_b32 s84, s71, 2
    s_lshl_b32 s70, s4, 2
    s_add_u32 s70, s70, s84
    s_mul_i32 s80, s70, 917504
    s_xor_b32 s85, s71, 3
    s_lshl_b32 s70, s4, 2
    s_add_u32 s70, s70, s85
    s_mul_i32 s81, s70, 917504
    s_waitcnt lgkmcnt(0)
    s_mov_b32 s32, s10
    s_and_b32 s33, s11, 0xffff
    s_mov_b32 s34, 0xe00000
    s_mov_b32 s35, 0x20000
    s_mov_b32 s36, s12
    s_and_b32 s37, s13, 0xffff
    s_mov_b32 s38, 0x1c000
    s_mov_b32 s39, 0x20000
    s_mov_b32 s40, s14
    s_and_b32 s41, s15, 0xffff
    s_mov_b32 s42, 0x1c000
    s_mov_b32 s43, 0x20000
    buffer_load_dwordx2 v[252:253], v9, s[36:39], 0 offen
    buffer_load_dwordx2 v[254:255], v9, s[40:43], 0 offen
    buffer_load_dwordx4 v[80:83], v8, s[32:35], s78 offen
    s_add_u32 s76, s78, 0x3800
    buffer_load_dwordx4 v[84:87], v8, s[32:35], s76 offen
    s_add_u32 s76, s78, 0x7000
    buffer_load_dwordx4 v[88:91], v8, s[32:35], s76 offen
    s_add_u32 s76, s78, 0xa800
    buffer_load_dwordx4 v[92:95], v8, s[32:35], s76 offen
    s_add_u32 s76, s78, 0x38000
    buffer_load_dwordx4 v[96:99], v8, s[32:35], s76 offen
    s_add_u32 s76, s78, 0x3b800
    buffer_load_dwordx4 v[100:103], v8, s[32:35], s76 offen
    s_add_u32 s76, s78, 0x3f000
    buffer_load_dwordx4 v[104:107], v8, s[32:35], s76 offen
    s_add_u32 s76, s78, 0x42800
    buffer_load_dwordx4 v[108:111], v8, s[32:35], s76 offen
    s_add_u32 s76, s78, 0x70000
    buffer_load_dwordx4 v[112:115], v8, s[32:35], s76 offen
    s_add_u32 s76, s78, 0x73800
    buffer_load_dwordx4 v[116:119], v8, s[32:35], s76 offen
    s_lshl_b32 s70, s61, 7
    s_add_u32 s70, s70, 0x308000
    s_load_dword s5, s[24:25], s70
    s_mov_b32 s48, s18
    s_and_b32 s49, s19, 0xffff
    s_mov_b32 s50, 0x1880000
    s_mov_b32 s51, 0x20000
    s_mov_b32 s52, s20
    s_and_b32 s53, s21, 0xffff
    s_mov_b32 s54, 0x1c0000
    s_mov_b32 s55, 0x20000
    s_mov_b32 s56, s24
    s_and_b32 s57, s25, 0xffff
    s_mov_b32 s58, 0x800000
    s_mov_b32 s59, 0x20000
    s_setreg_imm32_b32 hwreg(HW_REG_MODE, 4, 2), 3
    v_lshrrev_b32 v12, 2, v3
    v_lshrrev_b32 v13, 1, v12
    v_and_b32 v14, 1, v2
    v_lshl_add_u32 v13, v14, 1, v13
    v_lshl_add_u32 v12, v2, 3, v12
    v_lshlrev_b32 v12, 7, v12
    v_lshl_add_u32 v12, v13, 5, v12
    v_and_b32 v13, 3, v1
    v_lshl_add_u32 v12, v13, 3, v12
    v_add_u32 v12, s74, v12
    v_xor_b32 v13, 32, v12
    v_xor_b32 v14, 64, v12
    v_xor_b32 v15, 96, v12
    s_and_b32 s67, s60, 1
    s_lshr_b32 s70, s60, 1
    s_mul_i32 s68, s70, 14
    s_xor_b32 s70, s62, s67
    s_add_u32 s68, s68, s70
    s_lshl_b32 s70, s68, 7
    v_lshrrev_b32 v10, 3, v1
    v_and_b32 v11, 2, v10
    v_mul_u32_u24 v10, 7168, v10
    v_and_b32 v7, 7, v1
    v_xor_b32 v11, v11, v7
    v_lshl_add_u32 v10, v11, 4, v10
    v_add_u32 v10, s70, v10
    v_xor_b32 v11, 64, v10
    s_mul_i32 s70, s67, 64
    s_mul_i32 s71, s4, 12
    s_add_u32 s70, s70, s71
    s_mul_i32 s90, s70, 229376
    v_min_u32 v237, 5, v1
    v_lshlrev_b32 v237, 7, v237
    s_lshr_b32 s70, s70, 1
    s_mul_i32 s71, s61, 56
    s_add_u32 s71, s70, s71
    s_lshl_b32 s71, s71, 7
    s_add_u32 s7, s71, 0x304000
    s_add_u32 s88, s4, s66
    s_lshl_b32 s70, s65, 4
    s_add_u32 s70, s70, s4
    s_lshl_b32 s70, s70, 13
    s_lshl_b32 s71, s82, 11
    s_add_u32 s98, s70, s71
    s_lshl_b32 s71, s83, 11
    s_add_u32 s99, s70, s71
    s_lshl_b32 s71, s84, 11
    s_add_u32 s100, s70, s71
    s_lshl_b32 s71, s85, 11
    s_add_u32 s101, s70, s71
    v_min_u32 v236, 15, v1
    v_lshlrev_b32 v236, 7, v236
    s_lshl_b32 s70, s61, 13
    s_lshl_b32 s71, s4, 11
    s_add_u32 s70, s70, s71
    s_add_u32 s6, s70, 0x300000
    s_and_b32 s71, s88, 3
    s_lshl_b32 s72, s65, 2
    s_add_u32 s72, s72, s71
    s_mul_i32 s72, s72, 112
    s_lshl_b32 s73, s66, 1
    s_add_u32 s72, s72, s73
    s_lshl_b32 s72, s72, 10
    s_add_u32 s27, s72, 0x100000
    s_mul_i32 s70, s61, 56
    s_add_u32 s26, s70, s66
    s_lshl_b32 s26, s26, 7
    s_add_u32 s26, s26, 0x304000
    s_add_u32 s86, s26, 32768
    s_add_u32 s70, s74, 0
    v_add_u32 v232, s70, v4
    s_sub_u32 s71, s4, 1
    s_and_b32 s71, s71, 3
    s_mul_i32 s71, s71, 40960
    s_add_u32 s71, s71, 0
    v_add_u32 v233, s71, v4
    s_sub_u32 s71, s4, 2
    s_and_b32 s71, s71, 3
    s_mul_i32 s71, s71, 40960
    s_add_u32 s71, s71, 4096
    v_add_u32 v234, s71, v4
    s_sub_u32 s71, s4, 3
    s_and_b32 s71, s71, 3
    s_mul_i32 s71, s71, 40960
    s_add_u32 s71, s71, 8192
    v_add_u32 v235, s71, v4
    s_add_u32 s76, s78, 0x77000
    buffer_load_dwordx4 v[120:123], v8, s[32:35], s76 offen
    s_add_u32 s76, s78, 0x7a800
    buffer_load_dwordx4 v[124:127], v8, s[32:35], s76 offen
    s_add_u32 s76, s78, 0xa8000
    buffer_load_dwordx4 v[128:131], v8, s[32:35], s76 offen
    s_add_u32 s76, s78, 0xab800
    buffer_load_dwordx4 v[132:135], v8, s[32:35], s76 offen
    s_add_u32 s76, s78, 0xaf000
    buffer_load_dwordx4 v[136:139], v8, s[32:35], s76 offen
    s_add_u32 s76, s78, 0xb2800
    buffer_load_dwordx4 v[140:143], v8, s[32:35], s76 offen
    buffer_load_dwordx4 v[144:147], v8, s[32:35], s79 offen
    s_add_u32 s76, s79, 0x3800
    buffer_load_dwordx4 v[148:151], v8, s[32:35], s76 offen
    s_waitcnt vmcnt(18)
    s_waitcnt lgkmcnt(0)
    s_mul_i32 s69, s5, 0x9e3779b1
    s_add_u32 s69, s69, 0x7f4a7c15
    s_lshr_b32 s70, s69, 15
    s_xor_b32 s69, s69, s70
    s_mul_i32 s69, s69, 0x85ebca6b
    s_lshl_b32 s70, s82, 6
    v_lshl_add_u32 v239, v3, 2, s70
    ds_bpermute_b32 v248, v239, v252
    ds_bpermute_b32 v249, v239, v253
    ds_bpermute_b32 v250, v239, v254
    ds_bpermute_b32 v251, v239, v255
    s_mov_b32 s72, 0x71800000
    s_mov_b32 s73, 0xa7000000
    s_waitcnt lgkmcnt(0)
    v_lshlrev_b32 v240, 16, v248
    v_lshlrev_b32 v244, 16, v250
    v_and_b32 v241, 0xffff0000, v248
    v_and_b32 v245, 0xffff0000, v250
    v_lshlrev_b32 v242, 16, v249
    v_lshlrev_b32 v246, 16, v251
    v_and_b32 v243, 0xffff0000, v249
    v_and_b32 v247, 0xffff0000, v251
    v_mul_f32 v244, v244, v240
    v_mul_f32 v245, v245, v241
    v_mul_f32 v246, v246, v242
    v_mul_f32 v247, v247, v243
    v_mul_f32 v240, s72, v240
    v_mul_f32 v244, s73, v244
    v_mul_f32 v241, s72, v241
    v_mul_f32 v245, s73, v245
    v_mul_f32 v242, s72, v242
    v_mul_f32 v246, s73, v246
    v_mul_f32 v243, s72, v243
    v_mul_f32 v247, s73, v247
    s_waitcnt vmcnt(16)
    s_add_u32 s76, s79, 0x7000
    buffer_load_dwordx4 v[152:155], v8, s[32:35], s76 offen
    s_add_u32 s76, s79, 0xa800
    buffer_load_dwordx4 v[156:159], v8, s[32:35], s76 offen
    s_add_u32 s76, s79, 0x38000
    buffer_load_dwordx4 v[160:163], v8, s[32:35], s76 offen
    s_add_u32 s76, s79, 0x3b800
    buffer_load_dwordx4 v[164:167], v8, s[32:35], s76 offen
    v_pk_fma_f32 v[80:81], v[80:81], v[240:241], v[244:245]
    v_pk_fma_f32 v[82:83], v[82:83], v[242:243], v[246:247]
    v_pk_fma_f32 v[84:85], v[84:85], v[240:241], v[244:245]
    v_pk_fma_f32 v[86:87], v[86:87], v[242:243], v[246:247]
    v_cvt_pk_bf16_f32 v16, v80, v84
    v_cvt_pk_bf16_f32 v20, v81, v85
    v_cvt_pk_bf16_f32 v24, v82, v86
    v_cvt_pk_bf16_f32 v28, v83, v87
    s_waitcnt vmcnt(18)
    s_add_u32 s76, s79, 0x3f000
    buffer_load_dwordx4 v[168:171], v8, s[32:35], s76 offen
    s_add_u32 s76, s79, 0x42800
    buffer_load_dwordx4 v[172:175], v8, s[32:35], s76 offen
    v_pk_fma_f32 v[88:89], v[88:89], v[240:241], v[244:245]
    v_pk_fma_f32 v[90:91], v[90:91], v[242:243], v[246:247]
    v_pk_fma_f32 v[92:93], v[92:93], v[240:241], v[244:245]
    v_pk_fma_f32 v[94:95], v[94:95], v[242:243], v[246:247]
    v_cvt_pk_bf16_f32 v17, v88, v92
    v_cvt_pk_bf16_f32 v21, v89, v93
    v_cvt_pk_bf16_f32 v25, v90, v94
    v_cvt_pk_bf16_f32 v29, v91, v95
    s_waitcnt vmcnt(18)
    s_add_u32 s76, s79, 0x70000
    buffer_load_dwordx4 v[176:179], v8, s[32:35], s76 offen
    s_add_u32 s76, s79, 0x73800
    buffer_load_dwordx4 v[180:183], v8, s[32:35], s76 offen
    v_pk_fma_f32 v[96:97], v[96:97], v[240:241], v[244:245]
    v_pk_fma_f32 v[98:99], v[98:99], v[242:243], v[246:247]
    v_pk_fma_f32 v[100:101], v[100:101], v[240:241], v[244:245]
    v_pk_fma_f32 v[102:103], v[102:103], v[242:243], v[246:247]
    v_cvt_pk_bf16_f32 v18, v96, v100
    v_cvt_pk_bf16_f32 v22, v97, v101
    v_cvt_pk_bf16_f32 v26, v98, v102
    v_cvt_pk_bf16_f32 v30, v99, v103
    s_waitcnt vmcnt(18)
    s_add_u32 s76, s79, 0x77000
    buffer_load_dwordx4 v[184:187], v8, s[32:35], s76 offen
    s_add_u32 s76, s79, 0x7a800
    buffer_load_dwordx4 v[188:191], v8, s[32:35], s76 offen
    v_pk_fma_f32 v[104:105], v[104:105], v[240:241], v[244:245]
    v_pk_fma_f32 v[106:107], v[106:107], v[242:243], v[246:247]
    v_pk_fma_f32 v[108:109], v[108:109], v[240:241], v[244:245]
    v_pk_fma_f32 v[110:111], v[110:111], v[242:243], v[246:247]
    v_cvt_pk_bf16_f32 v19, v104, v108
    v_cvt_pk_bf16_f32 v23, v105, v109
    v_cvt_pk_bf16_f32 v27, v106, v110
    v_cvt_pk_bf16_f32 v31, v107, v111
    s_waitcnt vmcnt(18)
    s_add_u32 s76, s79, 0xa8000
    buffer_load_dwordx4 v[192:195], v8, s[32:35], s76 offen
    s_add_u32 s76, s79, 0xab800
    buffer_load_dwordx4 v[196:199], v8, s[32:35], s76 offen
    v_pk_fma_f32 v[112:113], v[112:113], v[240:241], v[244:245]
    v_pk_fma_f32 v[114:115], v[114:115], v[242:243], v[246:247]
    v_pk_fma_f32 v[116:117], v[116:117], v[240:241], v[244:245]
    v_pk_fma_f32 v[118:119], v[118:119], v[242:243], v[246:247]
    v_cvt_pk_bf16_f32 v32, v112, v116
    v_cvt_pk_bf16_f32 v36, v113, v117
    v_cvt_pk_bf16_f32 v40, v114, v118
    v_cvt_pk_bf16_f32 v44, v115, v119
    s_waitcnt vmcnt(18)
    s_add_u32 s76, s79, 0xaf000
    buffer_load_dwordx4 v[200:203], v8, s[32:35], s76 offen
    s_add_u32 s76, s79, 0xb2800
    buffer_load_dwordx4 v[204:207], v8, s[32:35], s76 offen
    v_pk_fma_f32 v[120:121], v[120:121], v[240:241], v[244:245]
    v_pk_fma_f32 v[122:123], v[122:123], v[242:243], v[246:247]
    v_pk_fma_f32 v[124:125], v[124:125], v[240:241], v[244:245]
    v_pk_fma_f32 v[126:127], v[126:127], v[242:243], v[246:247]
    v_cvt_pk_bf16_f32 v33, v120, v124
    v_cvt_pk_bf16_f32 v37, v121, v125
    v_cvt_pk_bf16_f32 v41, v122, v126
    v_cvt_pk_bf16_f32 v45, v123, v127
    s_waitcnt vmcnt(18)
    buffer_load_dwordx4 v[208:211], v8, s[32:35], s80 offen nt
    s_add_u32 s76, s80, 0x3800
    buffer_load_dwordx4 v[212:215], v8, s[32:35], s76 offen nt
    v_pk_fma_f32 v[128:129], v[128:129], v[240:241], v[244:245]
    v_pk_fma_f32 v[130:131], v[130:131], v[242:243], v[246:247]
    v_pk_fma_f32 v[132:133], v[132:133], v[240:241], v[244:245]
    v_pk_fma_f32 v[134:135], v[134:135], v[242:243], v[246:247]
    v_cvt_pk_bf16_f32 v34, v128, v132
    v_cvt_pk_bf16_f32 v38, v129, v133
    v_cvt_pk_bf16_f32 v42, v130, v134
    v_cvt_pk_bf16_f32 v46, v131, v135
    s_waitcnt vmcnt(18)
    s_add_u32 s76, s80, 0x7000
    buffer_load_dwordx4 v[216:219], v8, s[32:35], s76 offen nt
    s_add_u32 s76, s80, 0xa800
    buffer_load_dwordx4 v[220:223], v8, s[32:35], s76 offen nt
    v_pk_fma_f32 v[136:137], v[136:137], v[240:241], v[244:245]
    v_pk_fma_f32 v[138:139], v[138:139], v[242:243], v[246:247]
    v_pk_fma_f32 v[140:141], v[140:141], v[240:241], v[244:245]
    v_pk_fma_f32 v[142:143], v[142:143], v[242:243], v[246:247]
    v_cvt_pk_bf16_f32 v35, v136, v140
    v_cvt_pk_bf16_f32 v39, v137, v141
    v_cvt_pk_bf16_f32 v43, v138, v142
    v_cvt_pk_bf16_f32 v47, v139, v143
    s_lshl_b32 s70, s83, 6
    v_lshl_add_u32 v239, v3, 2, s70
    ds_bpermute_b32 v248, v239, v252
    ds_bpermute_b32 v249, v239, v253
    ds_bpermute_b32 v250, v239, v254
    ds_bpermute_b32 v251, v239, v255
    s_mov_b32 s72, 0x71800000
    s_mov_b32 s73, 0xa7000000
    s_waitcnt lgkmcnt(0)
    v_lshlrev_b32 v240, 16, v248
    v_lshlrev_b32 v244, 16, v250
    v_and_b32 v241, 0xffff0000, v248
    v_and_b32 v245, 0xffff0000, v250
    v_lshlrev_b32 v242, 16, v249
    v_lshlrev_b32 v246, 16, v251
    v_and_b32 v243, 0xffff0000, v249
    v_and_b32 v247, 0xffff0000, v251
    v_mul_f32 v244, v244, v240
    v_mul_f32 v245, v245, v241
    v_mul_f32 v246, v246, v242
    v_mul_f32 v247, v247, v243
    v_mul_f32 v240, s72, v240
    v_mul_f32 v244, s73, v244
    v_mul_f32 v241, s72, v241
    v_mul_f32 v245, s73, v245
    v_mul_f32 v242, s72, v242
    v_mul_f32 v246, s73, v246
    v_mul_f32 v243, s72, v243
    v_mul_f32 v247, s73, v247
    s_waitcnt vmcnt(18)
    v_pk_fma_f32 v[144:145], v[144:145], v[240:241], v[244:245]
    v_pk_fma_f32 v[146:147], v[146:147], v[242:243], v[246:247]
    v_pk_fma_f32 v[148:149], v[148:149], v[240:241], v[244:245]
    v_pk_fma_f32 v[150:151], v[150:151], v[242:243], v[246:247]
    v_cvt_pk_bf16_f32 v48, v144, v148
    v_cvt_pk_bf16_f32 v52, v145, v149
    v_cvt_pk_bf16_f32 v56, v146, v150
    v_cvt_pk_bf16_f32 v60, v147, v151
    s_waitcnt vmcnt(16)
    s_add_u32 s76, s80, 0x38000
    buffer_load_dwordx4 v[144:147], v8, s[32:35], s76 offen nt
    s_add_u32 s76, s80, 0x3b800
    buffer_load_dwordx4 v[148:151], v8, s[32:35], s76 offen nt
    v_pk_fma_f32 v[152:153], v[152:153], v[240:241], v[244:245]
    v_pk_fma_f32 v[154:155], v[154:155], v[242:243], v[246:247]
    v_pk_fma_f32 v[156:157], v[156:157], v[240:241], v[244:245]
    v_pk_fma_f32 v[158:159], v[158:159], v[242:243], v[246:247]
    v_cvt_pk_bf16_f32 v49, v152, v156
    v_cvt_pk_bf16_f32 v53, v153, v157
    v_cvt_pk_bf16_f32 v57, v154, v158
    v_cvt_pk_bf16_f32 v61, v155, v159
    s_waitcnt vmcnt(16)
    s_add_u32 s76, s80, 0x3f000
    buffer_load_dwordx4 v[152:155], v8, s[32:35], s76 offen nt
    s_add_u32 s76, s80, 0x42800
    buffer_load_dwordx4 v[156:159], v8, s[32:35], s76 offen nt
    v_pk_fma_f32 v[160:161], v[160:161], v[240:241], v[244:245]
    v_pk_fma_f32 v[162:163], v[162:163], v[242:243], v[246:247]
    v_pk_fma_f32 v[164:165], v[164:165], v[240:241], v[244:245]
    v_pk_fma_f32 v[166:167], v[166:167], v[242:243], v[246:247]
    v_cvt_pk_bf16_f32 v50, v160, v164
    v_cvt_pk_bf16_f32 v54, v161, v165
    v_cvt_pk_bf16_f32 v58, v162, v166
    v_cvt_pk_bf16_f32 v62, v163, v167
    s_waitcnt vmcnt(16)
    s_add_u32 s76, s80, 0x70000
    buffer_load_dwordx4 v[160:163], v8, s[32:35], s76 offen nt
    s_add_u32 s76, s80, 0x73800
    buffer_load_dwordx4 v[164:167], v8, s[32:35], s76 offen nt
    v_pk_fma_f32 v[168:169], v[168:169], v[240:241], v[244:245]
    v_pk_fma_f32 v[170:171], v[170:171], v[242:243], v[246:247]
    v_pk_fma_f32 v[172:173], v[172:173], v[240:241], v[244:245]
    v_pk_fma_f32 v[174:175], v[174:175], v[242:243], v[246:247]
    v_cvt_pk_bf16_f32 v51, v168, v172
    v_cvt_pk_bf16_f32 v55, v169, v173
    v_cvt_pk_bf16_f32 v59, v170, v174
    v_cvt_pk_bf16_f32 v63, v171, v175
    s_waitcnt vmcnt(16)
    s_add_u32 s76, s80, 0x77000
    buffer_load_dwordx4 v[168:171], v8, s[32:35], s76 offen nt
    s_add_u32 s76, s80, 0x7a800
    buffer_load_dwordx4 v[172:175], v8, s[32:35], s76 offen nt
    v_pk_fma_f32 v[176:177], v[176:177], v[240:241], v[244:245]
    v_pk_fma_f32 v[178:179], v[178:179], v[242:243], v[246:247]
    v_pk_fma_f32 v[180:181], v[180:181], v[240:241], v[244:245]
    v_pk_fma_f32 v[182:183], v[182:183], v[242:243], v[246:247]
    v_cvt_pk_bf16_f32 v64, v176, v180
    v_cvt_pk_bf16_f32 v68, v177, v181
    v_cvt_pk_bf16_f32 v72, v178, v182
    v_cvt_pk_bf16_f32 v76, v179, v183
    s_waitcnt vmcnt(16)
    s_add_u32 s76, s80, 0xa8000
    buffer_load_dwordx4 v[176:179], v8, s[32:35], s76 offen nt
    s_add_u32 s76, s80, 0xab800
    buffer_load_dwordx4 v[180:183], v8, s[32:35], s76 offen nt
    v_pk_fma_f32 v[184:185], v[184:185], v[240:241], v[244:245]
    v_pk_fma_f32 v[186:187], v[186:187], v[242:243], v[246:247]
    v_pk_fma_f32 v[188:189], v[188:189], v[240:241], v[244:245]
    v_pk_fma_f32 v[190:191], v[190:191], v[242:243], v[246:247]
    v_cvt_pk_bf16_f32 v65, v184, v188
    v_cvt_pk_bf16_f32 v69, v185, v189
    v_cvt_pk_bf16_f32 v73, v186, v190
    v_cvt_pk_bf16_f32 v77, v187, v191
    s_waitcnt vmcnt(16)
    s_add_u32 s76, s80, 0xaf000
    buffer_load_dwordx4 v[184:187], v8, s[32:35], s76 offen nt
    s_add_u32 s76, s80, 0xb2800
    buffer_load_dwordx4 v[188:191], v8, s[32:35], s76 offen nt
    v_pk_fma_f32 v[192:193], v[192:193], v[240:241], v[244:245]
    v_pk_fma_f32 v[194:195], v[194:195], v[242:243], v[246:247]
    v_pk_fma_f32 v[196:197], v[196:197], v[240:241], v[244:245]
    v_pk_fma_f32 v[198:199], v[198:199], v[242:243], v[246:247]
    v_cvt_pk_bf16_f32 v66, v192, v196
    v_cvt_pk_bf16_f32 v70, v193, v197
    v_cvt_pk_bf16_f32 v74, v194, v198
    v_cvt_pk_bf16_f32 v78, v195, v199
    s_waitcnt vmcnt(16)
    buffer_load_dwordx4 v[192:195], v8, s[32:35], s81 offen nt
    s_add_u32 s76, s81, 0x3800
    buffer_load_dwordx4 v[196:199], v8, s[32:35], s76 offen nt
    v_pk_fma_f32 v[200:201], v[200:201], v[240:241], v[244:245]
    v_pk_fma_f32 v[202:203], v[202:203], v[242:243], v[246:247]
    v_pk_fma_f32 v[204:205], v[204:205], v[240:241], v[244:245]
    v_pk_fma_f32 v[206:207], v[206:207], v[242:243], v[246:247]
    v_cvt_pk_bf16_f32 v67, v200, v204
    v_cvt_pk_bf16_f32 v71, v201, v205
    v_cvt_pk_bf16_f32 v75, v202, v206
    v_cvt_pk_bf16_f32 v79, v203, v207
    s_lshl_b32 s70, s84, 6
    v_lshl_add_u32 v239, v3, 2, s70
    ds_bpermute_b32 v248, v239, v252
    ds_bpermute_b32 v249, v239, v253
    ds_bpermute_b32 v250, v239, v254
    ds_bpermute_b32 v251, v239, v255
    s_mov_b32 s72, 0x71800000
    s_mov_b32 s73, 0xa7000000
    s_waitcnt lgkmcnt(0)
    v_lshlrev_b32 v240, 16, v248
    v_lshlrev_b32 v244, 16, v250
    v_and_b32 v241, 0xffff0000, v248
    v_and_b32 v245, 0xffff0000, v250
    v_lshlrev_b32 v242, 16, v249
    v_lshlrev_b32 v246, 16, v251
    v_and_b32 v243, 0xffff0000, v249
    v_and_b32 v247, 0xffff0000, v251
    v_mul_f32 v244, v244, v240
    v_mul_f32 v245, v245, v241
    v_mul_f32 v246, v246, v242
    v_mul_f32 v247, v247, v243
    v_mul_f32 v240, s72, v240
    v_mul_f32 v244, s73, v244
    v_mul_f32 v241, s72, v241
    v_mul_f32 v245, s73, v245
    v_mul_f32 v242, s72, v242
    v_mul_f32 v246, s73, v246
    v_mul_f32 v243, s72, v243
    v_mul_f32 v247, s73, v247
    s_waitcnt vmcnt(16)
    v_pk_fma_f32 v[208:209], v[208:209], v[240:241], v[244:245]
    v_pk_fma_f32 v[210:211], v[210:211], v[242:243], v[246:247]
    v_pk_fma_f32 v[212:213], v[212:213], v[240:241], v[244:245]
    v_pk_fma_f32 v[214:215], v[214:215], v[242:243], v[246:247]
    v_cvt_pk_bf16_f32 v80, v208, v212
    v_cvt_pk_bf16_f32 v84, v209, v213
    v_cvt_pk_bf16_f32 v88, v210, v214
    v_cvt_pk_bf16_f32 v92, v211, v215
    s_waitcnt vmcnt(14)
    v_pk_fma_f32 v[216:217], v[216:217], v[240:241], v[244:245]
    v_pk_fma_f32 v[218:219], v[218:219], v[242:243], v[246:247]
    v_pk_fma_f32 v[220:221], v[220:221], v[240:241], v[244:245]
    v_pk_fma_f32 v[222:223], v[222:223], v[242:243], v[246:247]
    v_cvt_pk_bf16_f32 v81, v216, v220
    v_cvt_pk_bf16_f32 v85, v217, v221
    v_cvt_pk_bf16_f32 v89, v218, v222
    v_cvt_pk_bf16_f32 v93, v219, v223
    s_waitcnt vmcnt(12)
    v_pk_fma_f32 v[144:145], v[144:145], v[240:241], v[244:245]
    v_pk_fma_f32 v[146:147], v[146:147], v[242:243], v[246:247]
    v_pk_fma_f32 v[148:149], v[148:149], v[240:241], v[244:245]
    v_pk_fma_f32 v[150:151], v[150:151], v[242:243], v[246:247]
    v_cvt_pk_bf16_f32 v82, v144, v148
    v_cvt_pk_bf16_f32 v86, v145, v149
    v_cvt_pk_bf16_f32 v90, v146, v150
    v_cvt_pk_bf16_f32 v94, v147, v151
    s_waitcnt vmcnt(10)
    s_add_u32 s76, s81, 0x7000
    buffer_load_dwordx4 v[200:203], v8, s[32:35], s76 offen nt
    s_add_u32 s76, s81, 0xa800
    buffer_load_dwordx4 v[204:207], v8, s[32:35], s76 offen nt
    v_pk_fma_f32 v[152:153], v[152:153], v[240:241], v[244:245]
    v_pk_fma_f32 v[154:155], v[154:155], v[242:243], v[246:247]
    v_pk_fma_f32 v[156:157], v[156:157], v[240:241], v[244:245]
    v_pk_fma_f32 v[158:159], v[158:159], v[242:243], v[246:247]
    v_cvt_pk_bf16_f32 v83, v152, v156
    v_cvt_pk_bf16_f32 v87, v153, v157
    v_cvt_pk_bf16_f32 v91, v154, v158
    v_cvt_pk_bf16_f32 v95, v155, v159
    s_waitcnt vmcnt(10)
    s_add_u32 s76, s81, 0x38000
    buffer_load_dwordx4 v[208:211], v8, s[32:35], s76 offen nt
    s_add_u32 s76, s81, 0x3b800
    buffer_load_dwordx4 v[212:215], v8, s[32:35], s76 offen nt
    v_pk_fma_f32 v[160:161], v[160:161], v[240:241], v[244:245]
    v_pk_fma_f32 v[162:163], v[162:163], v[242:243], v[246:247]
    v_pk_fma_f32 v[164:165], v[164:165], v[240:241], v[244:245]
    v_pk_fma_f32 v[166:167], v[166:167], v[242:243], v[246:247]
    v_cvt_pk_bf16_f32 v96, v160, v164
    v_cvt_pk_bf16_f32 v100, v161, v165
    v_cvt_pk_bf16_f32 v104, v162, v166
    v_cvt_pk_bf16_f32 v108, v163, v167
    s_waitcnt vmcnt(10)
    s_add_u32 s76, s81, 0x3f000
    buffer_load_dwordx4 v[216:219], v8, s[32:35], s76 offen nt
    s_add_u32 s76, s81, 0x42800
    buffer_load_dwordx4 v[220:223], v8, s[32:35], s76 offen nt
    v_pk_fma_f32 v[168:169], v[168:169], v[240:241], v[244:245]
    v_pk_fma_f32 v[170:171], v[170:171], v[242:243], v[246:247]
    v_pk_fma_f32 v[172:173], v[172:173], v[240:241], v[244:245]
    v_pk_fma_f32 v[174:175], v[174:175], v[242:243], v[246:247]
    v_cvt_pk_bf16_f32 v97, v168, v172
    v_cvt_pk_bf16_f32 v101, v169, v173
    v_cvt_pk_bf16_f32 v105, v170, v174
    v_cvt_pk_bf16_f32 v109, v171, v175
    s_waitcnt vmcnt(10)
    buffer_load_dword v238, v236, s[56:59], s6 offen sc1
    s_add_u32 s76, s81, 0x70000
    buffer_load_dwordx4 v[144:147], v8, s[32:35], s76 offen nt
    v_pk_fma_f32 v[176:177], v[176:177], v[240:241], v[244:245]
    v_pk_fma_f32 v[178:179], v[178:179], v[242:243], v[246:247]
    v_pk_fma_f32 v[180:181], v[180:181], v[240:241], v[244:245]
    v_pk_fma_f32 v[182:183], v[182:183], v[242:243], v[246:247]
    v_cvt_pk_bf16_f32 v98, v176, v180
    v_cvt_pk_bf16_f32 v102, v177, v181
    v_cvt_pk_bf16_f32 v106, v178, v182
    v_cvt_pk_bf16_f32 v110, v179, v183
    s_waitcnt vmcnt(10)
    s_add_u32 s76, s81, 0x73800
    buffer_load_dwordx4 v[148:151], v8, s[32:35], s76 offen nt
    s_add_u32 s76, s81, 0x77000
    buffer_load_dwordx4 v[152:155], v8, s[32:35], s76 offen nt
    v_pk_fma_f32 v[184:185], v[184:185], v[240:241], v[244:245]
    v_pk_fma_f32 v[186:187], v[186:187], v[242:243], v[246:247]
    v_pk_fma_f32 v[188:189], v[188:189], v[240:241], v[244:245]
    v_pk_fma_f32 v[190:191], v[190:191], v[242:243], v[246:247]
    v_cvt_pk_bf16_f32 v99, v184, v188
    v_cvt_pk_bf16_f32 v103, v185, v189
    v_cvt_pk_bf16_f32 v107, v186, v190
    v_cvt_pk_bf16_f32 v111, v187, v191
    s_lshl_b32 s70, s85, 6
    v_lshl_add_u32 v239, v3, 2, s70
    ds_bpermute_b32 v248, v239, v252
    ds_bpermute_b32 v249, v239, v253
    ds_bpermute_b32 v250, v239, v254
    ds_bpermute_b32 v251, v239, v255
    s_mov_b32 s72, 0x71800000
    s_mov_b32 s73, 0xa7000000
    s_waitcnt lgkmcnt(0)
    v_lshlrev_b32 v240, 16, v248
    v_lshlrev_b32 v244, 16, v250
    v_and_b32 v241, 0xffff0000, v248
    v_and_b32 v245, 0xffff0000, v250
    v_lshlrev_b32 v242, 16, v249
    v_lshlrev_b32 v246, 16, v251
    v_and_b32 v243, 0xffff0000, v249
    v_and_b32 v247, 0xffff0000, v251
    v_mul_f32 v244, v244, v240
    v_mul_f32 v245, v245, v241
    v_mul_f32 v246, v246, v242
    v_mul_f32 v247, v247, v243
    v_mul_f32 v240, s72, v240
    v_mul_f32 v244, s73, v244
    v_mul_f32 v241, s72, v241
    v_mul_f32 v245, s73, v245
    v_mul_f32 v242, s72, v242
    v_mul_f32 v246, s73, v246
    v_mul_f32 v243, s72, v243
    v_mul_f32 v247, s73, v247
    s_waitcnt vmcnt(10)
    s_add_u32 s76, s81, 0x7a800
    buffer_load_dwordx4 v[156:159], v8, s[32:35], s76 offen nt
    s_add_u32 s76, s81, 0xa8000
    buffer_load_dwordx4 v[160:163], v8, s[32:35], s76 offen nt
    v_pk_fma_f32 v[192:193], v[192:193], v[240:241], v[244:245]
    v_pk_fma_f32 v[194:195], v[194:195], v[242:243], v[246:247]
    v_pk_fma_f32 v[196:197], v[196:197], v[240:241], v[244:245]
    v_pk_fma_f32 v[198:199], v[198:199], v[242:243], v[246:247]
    v_cvt_pk_bf16_f32 v112, v192, v196
    v_cvt_pk_bf16_f32 v116, v193, v197
    v_cvt_pk_bf16_f32 v120, v194, v198
    v_cvt_pk_bf16_f32 v124, v195, v199
    s_waitcnt vmcnt(10)
    s_add_u32 s76, s81, 0xab800
    buffer_load_dwordx4 v[164:167], v8, s[32:35], s76 offen nt
    s_add_u32 s76, s81, 0xaf000
    buffer_load_dwordx4 v[168:171], v8, s[32:35], s76 offen nt
    v_pk_fma_f32 v[200:201], v[200:201], v[240:241], v[244:245]
    v_pk_fma_f32 v[202:203], v[202:203], v[242:243], v[246:247]
    v_pk_fma_f32 v[204:205], v[204:205], v[240:241], v[244:245]
    v_pk_fma_f32 v[206:207], v[206:207], v[242:243], v[246:247]
    v_cvt_pk_bf16_f32 v113, v200, v204
    v_cvt_pk_bf16_f32 v117, v201, v205
    v_cvt_pk_bf16_f32 v121, v202, v206
    v_cvt_pk_bf16_f32 v125, v203, v207
    s_waitcnt vmcnt(10)
    s_add_u32 s76, s81, 0xb2800
    buffer_load_dwordx4 v[172:175], v8, s[32:35], s76 offen nt
    v_pk_fma_f32 v[208:209], v[208:209], v[240:241], v[244:245]
    v_pk_fma_f32 v[210:211], v[210:211], v[242:243], v[246:247]
    v_pk_fma_f32 v[212:213], v[212:213], v[240:241], v[244:245]
    v_pk_fma_f32 v[214:215], v[214:215], v[242:243], v[246:247]
    v_cvt_pk_bf16_f32 v114, v208, v212
    v_cvt_pk_bf16_f32 v118, v209, v213
    v_cvt_pk_bf16_f32 v122, v210, v214
    v_cvt_pk_bf16_f32 v126, v211, v215
    s_waitcnt vmcnt(9)
    v_pk_fma_f32 v[216:217], v[216:217], v[240:241], v[244:245]
    v_pk_fma_f32 v[218:219], v[218:219], v[242:243], v[246:247]
    v_pk_fma_f32 v[220:221], v[220:221], v[240:241], v[244:245]
    v_pk_fma_f32 v[222:223], v[222:223], v[242:243], v[246:247]
    v_cvt_pk_bf16_f32 v115, v216, v220
    v_cvt_pk_bf16_f32 v119, v217, v221
    v_cvt_pk_bf16_f32 v123, v218, v222
    v_cvt_pk_bf16_f32 v127, v219, v223
    s_waitcnt vmcnt(6)
    v_cmp_ne_u32 vcc, s69, v238
    s_mov_b32 s75, 0
    s_cbranch_vccz POLLX_8
POLL_7:
    s_sleep 8
    buffer_load_dword v238, v236, s[56:59], s6 offen sc1
    s_add_u32 s75, s75, 1
    s_waitcnt vmcnt(0)
    v_cmp_ne_u32 vcc, s69, v238
    s_cmp_gt_u32 s75, 0x40000
    s_cbranch_scc1 POLLX_8
    s_cbranch_vccnz POLL_7
POLLX_8:
    s_add_u32 s77, s88, 1
    s_and_b32 s77, s77, 3
    s_lshl_b32 s77, s77, 15
    s_add_u32 s76, s98, s77
    buffer_load_dwordx4 a[0:3], v4, s[56:59], s76 offen offset:0 sc1
    buffer_load_dwordx4 a[4:7], v4, s[56:59], s76 offen offset:1024 sc1
    s_add_u32 s76, s99, s77
    buffer_load_dwordx4 a[8:11], v4, s[56:59], s76 offen offset:0 sc1
    buffer_load_dwordx4 a[12:15], v4, s[56:59], s76 offen offset:1024 sc1
    s_add_u32 s76, s100, s77
    buffer_load_dwordx4 a[16:19], v4, s[56:59], s76 offen offset:0 sc1
    buffer_load_dwordx4 a[20:23], v4, s[56:59], s76 offen offset:1024 sc1
    v_pk_fma_f32 v[144:145], v[144:145], v[240:241], v[244:245]
    v_pk_fma_f32 v[146:147], v[146:147], v[242:243], v[246:247]
    v_pk_fma_f32 v[148:149], v[148:149], v[240:241], v[244:245]
    v_pk_fma_f32 v[150:151], v[150:151], v[242:243], v[246:247]
    v_cvt_pk_bf16_f32 v128, v144, v148
    v_cvt_pk_bf16_f32 v132, v145, v149
    v_cvt_pk_bf16_f32 v136, v146, v150
    v_cvt_pk_bf16_f32 v140, v147, v151
    s_waitcnt vmcnt(10)
    s_add_u32 s76, s101, s77
    buffer_load_dwordx4 a[24:27], v4, s[56:59], s76 offen offset:0 sc1
    buffer_load_dwordx4 a[28:31], v4, s[56:59], s76 offen offset:1024 sc1
    v_pk_fma_f32 v[152:153], v[152:153], v[240:241], v[244:245]
    v_pk_fma_f32 v[154:155], v[154:155], v[242:243], v[246:247]
    v_pk_fma_f32 v[156:157], v[156:157], v[240:241], v[244:245]
    v_pk_fma_f32 v[158:159], v[158:159], v[242:243], v[246:247]
    v_cvt_pk_bf16_f32 v129, v152, v156
    v_cvt_pk_bf16_f32 v133, v153, v157
    v_cvt_pk_bf16_f32 v137, v154, v158
    v_cvt_pk_bf16_f32 v141, v155, v159
    s_waitcnt vmcnt(10)
    s_add_u32 s77, s88, 2
    s_and_b32 s77, s77, 3
    s_lshl_b32 s77, s77, 15
    s_add_u32 s76, s98, s77
    buffer_load_dwordx4 a[32:35], v4, s[56:59], s76 offen offset:0 sc1
    buffer_load_dwordx4 a[36:39], v4, s[56:59], s76 offen offset:1024 sc1
    v_pk_fma_f32 v[160:161], v[160:161], v[240:241], v[244:245]
    v_pk_fma_f32 v[162:163], v[162:163], v[242:243], v[246:247]
    v_pk_fma_f32 v[164:165], v[164:165], v[240:241], v[244:245]
    v_pk_fma_f32 v[166:167], v[166:167], v[242:243], v[246:247]
    v_cvt_pk_bf16_f32 v130, v160, v164
    v_cvt_pk_bf16_f32 v134, v161, v165
    v_cvt_pk_bf16_f32 v138, v162, v166
    v_cvt_pk_bf16_f32 v142, v163, v167
    s_waitcnt vmcnt(10)
    s_add_u32 s76, s99, s77
    buffer_load_dwordx4 a[40:43], v4, s[56:59], s76 offen offset:0 sc1
    buffer_load_dwordx4 a[44:47], v4, s[56:59], s76 offen offset:1024 sc1
    v_pk_fma_f32 v[168:169], v[168:169], v[240:241], v[244:245]
    v_pk_fma_f32 v[170:171], v[170:171], v[242:243], v[246:247]
    v_pk_fma_f32 v[172:173], v[172:173], v[240:241], v[244:245]
    v_pk_fma_f32 v[174:175], v[174:175], v[242:243], v[246:247]
    v_cvt_pk_bf16_f32 v131, v168, v172
    v_cvt_pk_bf16_f32 v135, v169, v173
    v_cvt_pk_bf16_f32 v139, v170, v174
    v_cvt_pk_bf16_f32 v143, v171, v175
    s_waitcnt vmcnt(11)
    v_mfma_f32_16x16x32_bf16 a[224:227], v[16:19], a[0:3], 0
    s_add_u32 s76, s100, s77
    buffer_load_dwordx4 a[48:51], v4, s[56:59], s76 offen offset:0 sc1
    v_mfma_f32_16x16x32_bf16 a[228:231], v[20:23], a[0:3], 0
    v_mfma_f32_16x16x32_bf16 a[232:235], v[24:27], a[0:3], 0
    v_mfma_f32_16x16x32_bf16 a[236:239], v[28:31], a[0:3], 0
    s_waitcnt vmcnt(11)
    v_mfma_f32_16x16x32_bf16 a[224:227], v[32:35], a[4:7], a[224:227]
    buffer_load_dwordx4 a[52:55], v4, s[56:59], s76 offen offset:1024 sc1
    v_mfma_f32_16x16x32_bf16 a[228:231], v[36:39], a[4:7], a[228:231]
    v_mfma_f32_16x16x32_bf16 a[232:235], v[40:43], a[4:7], a[232:235]
    v_mfma_f32_16x16x32_bf16 a[236:239], v[44:47], a[4:7], a[236:239]
    s_waitcnt vmcnt(11)
    v_mfma_f32_16x16x32_bf16 a[224:227], v[48:51], a[8:11], a[224:227]
    s_add_u32 s76, s101, s77
    buffer_load_dwordx4 a[56:59], v4, s[56:59], s76 offen offset:0 sc1
    v_mfma_f32_16x16x32_bf16 a[228:231], v[52:55], a[8:11], a[228:231]
    v_mfma_f32_16x16x32_bf16 a[232:235], v[56:59], a[8:11], a[232:235]
    v_mfma_f32_16x16x32_bf16 a[236:239], v[60:63], a[8:11], a[236:239]
    s_waitcnt vmcnt(11)
    v_mfma_f32_16x16x32_bf16 a[224:227], v[64:67], a[12:15], a[224:227]
    buffer_load_dwordx4 a[60:63], v4, s[56:59], s76 offen offset:1024 sc1
    v_mfma_f32_16x16x32_bf16 a[228:231], v[68:71], a[12:15], a[228:231]
    v_mfma_f32_16x16x32_bf16 a[232:235], v[72:75], a[12:15], a[232:235]
    v_mfma_f32_16x16x32_bf16 a[236:239], v[76:79], a[12:15], a[236:239]
    s_waitcnt vmcnt(11)
    v_mfma_f32_16x16x32_bf16 a[224:227], v[80:83], a[16:19], a[224:227]
    s_add_u32 s77, s88, 3
    s_and_b32 s77, s77, 3
    s_lshl_b32 s77, s77, 15
    s_add_u32 s76, s98, s77
    buffer_load_dwordx4 a[0:3], v4, s[56:59], s76 offen offset:0 sc1
    v_mfma_f32_16x16x32_bf16 a[228:231], v[84:87], a[16:19], a[228:231]
    v_mfma_f32_16x16x32_bf16 a[232:235], v[88:91], a[16:19], a[232:235]
    v_mfma_f32_16x16x32_bf16 a[236:239], v[92:95], a[16:19], a[236:239]
    s_waitcnt vmcnt(11)
    v_mfma_f32_16x16x32_bf16 a[224:227], v[96:99], a[20:23], a[224:227]
    buffer_load_dwordx4 a[4:7], v4, s[56:59], s76 offen offset:1024 sc1
    v_mfma_f32_16x16x32_bf16 a[228:231], v[100:103], a[20:23], a[228:231]
    v_mfma_f32_16x16x32_bf16 a[232:235], v[104:107], a[20:23], a[232:235]
    v_mfma_f32_16x16x32_bf16 a[236:239], v[108:111], a[20:23], a[236:239]
    s_waitcnt vmcnt(11)
    v_mfma_f32_16x16x32_bf16 a[224:227], v[112:115], a[24:27], a[224:227]
    s_add_u32 s76, s99, s77
    buffer_load_dwordx4 a[8:11], v4, s[56:59], s76 offen offset:0 sc1
    v_mfma_f32_16x16x32_bf16 a[228:231], v[116:119], a[24:27], a[228:231]
    v_mfma_f32_16x16x32_bf16 a[232:235], v[120:123], a[24:27], a[232:235]
    v_mfma_f32_16x16x32_bf16 a[236:239], v[124:127], a[24:27], a[236:239]
    s_waitcnt vmcnt(11)
    v_mfma_f32_16x16x32_bf16 a[224:227], v[128:131], a[28:31], a[224:227]
    buffer_load_dwordx4 a[12:15], v4, s[56:59], s76 offen offset:1024 sc1
    v_mfma_f32_16x16x32_bf16 a[228:231], v[132:135], a[28:31], a[228:231]
    v_mfma_f32_16x16x32_bf16 a[232:235], v[136:139], a[28:31], a[232:235]
    v_mfma_f32_16x16x32_bf16 a[236:239], v[140:143], a[28:31], a[236:239]
    s_waitcnt vmcnt(11)
    v_mfma_f32_16x16x32_bf16 a[240:243], v[16:19], a[32:35], 0
    s_add_u32 s76, s100, s77
    buffer_load_dwordx4 a[16:19], v4, s[56:59], s76 offen offset:0 sc1
    v_mfma_f32_16x16x32_bf16 a[244:247], v[20:23], a[32:35], 0
    v_mfma_f32_16x16x32_bf16 a[248:251], v[24:27], a[32:35], 0
    v_mfma_f32_16x16x32_bf16 a[252:255], v[28:31], a[32:35], 0
    s_waitcnt vmcnt(11)
    v_mfma_f32_16x16x32_bf16 a[240:243], v[32:35], a[36:39], a[240:243]
    buffer_load_dwordx4 a[20:23], v4, s[56:59], s76 offen offset:1024 sc1
    v_mfma_f32_16x16x32_bf16 a[244:247], v[36:39], a[36:39], a[244:247]
    v_mfma_f32_16x16x32_bf16 a[248:251], v[40:43], a[36:39], a[248:251]
    v_mfma_f32_16x16x32_bf16 a[252:255], v[44:47], a[36:39], a[252:255]
    s_waitcnt vmcnt(11)
    v_mfma_f32_16x16x32_bf16 a[240:243], v[48:51], a[40:43], a[240:243]
    s_add_u32 s76, s101, s77
    buffer_load_dwordx4 a[24:27], v4, s[56:59], s76 offen offset:0 sc1
    v_mfma_f32_16x16x32_bf16 a[244:247], v[52:55], a[40:43], a[244:247]
    ds_write_b128 v232, a[224:227] offset:0
    ds_write_b128 v232, a[228:231] offset:1024
    v_mfma_f32_16x16x32_bf16 a[248:251], v[56:59], a[40:43], a[248:251]
    ds_write_b128 v232, a[232:235] offset:2048
    ds_write_b128 v232, a[236:239] offset:3072
    v_mfma_f32_16x16x32_bf16 a[252:255], v[60:63], a[40:43], a[252:255]
    s_waitcnt vmcnt(11)
    v_mfma_f32_16x16x32_bf16 a[240:243], v[64:67], a[44:47], a[240:243]
    buffer_load_dwordx4 a[28:31], v4, s[56:59], s76 offen offset:1024 sc1
    v_mfma_f32_16x16x32_bf16 a[244:247], v[68:71], a[44:47], a[244:247]
    v_mfma_f32_16x16x32_bf16 a[248:251], v[72:75], a[44:47], a[248:251]
    v_mfma_f32_16x16x32_bf16 a[252:255], v[76:79], a[44:47], a[252:255]
    s_waitcnt vmcnt(11)
    v_mfma_f32_16x16x32_bf16 a[240:243], v[80:83], a[48:51], a[240:243]
    s_add_u32 s77, s88, 4
    s_and_b32 s77, s77, 3
    s_lshl_b32 s77, s77, 15
    s_add_u32 s76, s98, s77
    buffer_load_dwordx4 a[32:35], v4, s[56:59], s76 offen offset:0 sc1
    v_mfma_f32_16x16x32_bf16 a[244:247], v[84:87], a[48:51], a[244:247]
    v_mfma_f32_16x16x32_bf16 a[248:251], v[88:91], a[48:51], a[248:251]
    v_mfma_f32_16x16x32_bf16 a[252:255], v[92:95], a[48:51], a[252:255]
    s_waitcnt vmcnt(11)
    v_mfma_f32_16x16x32_bf16 a[240:243], v[96:99], a[52:55], a[240:243]
    buffer_load_dwordx4 a[36:39], v4, s[56:59], s76 offen offset:1024 sc1
    v_mfma_f32_16x16x32_bf16 a[244:247], v[100:103], a[52:55], a[244:247]
    v_mfma_f32_16x16x32_bf16 a[248:251], v[104:107], a[52:55], a[248:251]
    v_mfma_f32_16x16x32_bf16 a[252:255], v[108:111], a[52:55], a[252:255]
    s_waitcnt vmcnt(11)
    v_mfma_f32_16x16x32_bf16 a[240:243], v[112:115], a[56:59], a[240:243]
    s_add_u32 s76, s99, s77
    buffer_load_dwordx4 a[40:43], v4, s[56:59], s76 offen offset:0 sc1
    v_mfma_f32_16x16x32_bf16 a[244:247], v[116:119], a[56:59], a[244:247]
    v_mfma_f32_16x16x32_bf16 a[248:251], v[120:123], a[56:59], a[248:251]
    v_mfma_f32_16x16x32_bf16 a[252:255], v[124:127], a[56:59], a[252:255]
    s_waitcnt vmcnt(11)
    v_mfma_f32_16x16x32_bf16 a[240:243], v[128:131], a[60:63], a[240:243]
    buffer_load_dwordx4 a[44:47], v4, s[56:59], s76 offen offset:1024 sc1
    v_mfma_f32_16x16x32_bf16 a[244:247], v[132:135], a[60:63], a[244:247]
    v_mfma_f32_16x16x32_bf16 a[248:251], v[136:139], a[60:63], a[248:251]
    v_mfma_f32_16x16x32_bf16 a[252:255], v[140:143], a[60:63], a[252:255]
    s_waitcnt vmcnt(11)
    v_mfma_f32_16x16x32_bf16 a[224:227], v[16:19], a[0:3], 0
    s_add_u32 s76, s100, s77
    buffer_load_dwordx4 a[48:51], v4, s[56:59], s76 offen offset:0 sc1
    v_mfma_f32_16x16x32_bf16 a[228:231], v[20:23], a[0:3], 0
    v_mfma_f32_16x16x32_bf16 a[232:235], v[24:27], a[0:3], 0
    v_mfma_f32_16x16x32_bf16 a[236:239], v[28:31], a[0:3], 0
    s_waitcnt vmcnt(11)
    v_mfma_f32_16x16x32_bf16 a[224:227], v[32:35], a[4:7], a[224:227]
    buffer_load_dwordx4 a[52:55], v4, s[56:59], s76 offen offset:1024 sc1
    v_mfma_f32_16x16x32_bf16 a[228:231], v[36:39], a[4:7], a[228:231]
    v_mfma_f32_16x16x32_bf16 a[232:235], v[40:43], a[4:7], a[232:235]
    v_mfma_f32_16x16x32_bf16 a[236:239], v[44:47], a[4:7], a[236:239]
    s_waitcnt vmcnt(11)
    v_mfma_f32_16x16x32_bf16 a[224:227], v[48:51], a[8:11], a[224:227]
    s_add_u32 s76, s101, s77
    buffer_load_dwordx4 a[56:59], v4, s[56:59], s76 offen offset:0 sc1
    v_mfma_f32_16x16x32_bf16 a[228:231], v[52:55], a[8:11], a[228:231]
    ds_write_b128 v232, a[240:243] offset:4096
    ds_write_b128 v232, a[244:247] offset:5120
    v_mfma_f32_16x16x32_bf16 a[232:235], v[56:59], a[8:11], a[232:235]
    ds_write_b128 v232, a[248:251] offset:6144
    ds_write_b128 v232, a[252:255] offset:7168
    v_mfma_f32_16x16x32_bf16 a[236:239], v[60:63], a[8:11], a[236:239]
    s_waitcnt vmcnt(11)
    v_mfma_f32_16x16x32_bf16 a[224:227], v[64:67], a[12:15], a[224:227]
    buffer_load_dwordx4 a[60:63], v4, s[56:59], s76 offen offset:1024 sc1
    v_mfma_f32_16x16x32_bf16 a[228:231], v[68:71], a[12:15], a[228:231]
    v_mfma_f32_16x16x32_bf16 a[232:235], v[72:75], a[12:15], a[232:235]
    v_mfma_f32_16x16x32_bf16 a[236:239], v[76:79], a[12:15], a[236:239]
    s_waitcnt vmcnt(11)
    v_mfma_f32_16x16x32_bf16 a[224:227], v[80:83], a[16:19], a[224:227]
    s_add_u32 s77, s88, 1
    s_and_b32 s77, s77, 3
    s_add_u32 s77, s77, 4
    s_lshl_b32 s77, s77, 15
    s_add_u32 s76, s98, s77
    buffer_load_dwordx4 a[0:3], v4, s[56:59], s76 offen offset:0 sc1
    v_mfma_f32_16x16x32_bf16 a[228:231], v[84:87], a[16:19], a[228:231]
    v_mfma_f32_16x16x32_bf16 a[232:235], v[88:91], a[16:19], a[232:235]
    v_mfma_f32_16x16x32_bf16 a[236:239], v[92:95], a[16:19], a[236:239]
    s_waitcnt vmcnt(11)
    v_mfma_f32_16x16x32_bf16 a[224:227], v[96:99], a[20:23], a[224:227]
    buffer_load_dwordx4 a[4:7], v4, s[56:59], s76 offen offset:1024 sc1
    v_mfma_f32_16x16x32_bf16 a[228:231], v[100:103], a[20:23], a[228:231]
    v_mfma_f32_16x16x32_bf16 a[232:235], v[104:107], a[20:23], a[232:235]
    v_mfma_f32_16x16x32_bf16 a[236:239], v[108:111], a[20:23], a[236:239]
    s_waitcnt vmcnt(11)
    v_mfma_f32_16x16x32_bf16 a[224:227], v[112:115], a[24:27], a[224:227]
    s_add_u32 s76, s99, s77
    buffer_load_dwordx4 a[8:11], v4, s[56:59], s76 offen offset:0 sc1
    v_mfma_f32_16x16x32_bf16 a[228:231], v[116:119], a[24:27], a[228:231]
    v_mfma_f32_16x16x32_bf16 a[232:235], v[120:123], a[24:27], a[232:235]
    v_mfma_f32_16x16x32_bf16 a[236:239], v[124:127], a[24:27], a[236:239]
    s_waitcnt vmcnt(11)
    v_mfma_f32_16x16x32_bf16 a[224:227], v[128:131], a[28:31], a[224:227]
    buffer_load_dwordx4 a[12:15], v4, s[56:59], s76 offen offset:1024 sc1
    v_mfma_f32_16x16x32_bf16 a[228:231], v[132:135], a[28:31], a[228:231]
    v_mfma_f32_16x16x32_bf16 a[232:235], v[136:139], a[28:31], a[232:235]
    v_mfma_f32_16x16x32_bf16 a[236:239], v[140:143], a[28:31], a[236:239]
    s_waitcnt vmcnt(11)
    v_mfma_f32_16x16x32_bf16 v[240:243], v[16:19], a[32:35], 0
    s_add_u32 s76, s100, s77
    buffer_load_dwordx4 a[16:19], v4, s[56:59], s76 offen offset:0 sc1
    v_mfma_f32_16x16x32_bf16 v[244:247], v[20:23], a[32:35], 0
    v_mfma_f32_16x16x32_bf16 v[248:251], v[24:27], a[32:35], 0
    v_mfma_f32_16x16x32_bf16 v[252:255], v[28:31], a[32:35], 0
    s_waitcnt vmcnt(11)
    v_mfma_f32_16x16x32_bf16 v[240:243], v[32:35], a[36:39], v[240:243]
    buffer_load_dwordx4 a[20:23], v4, s[56:59], s76 offen offset:1024 sc1
    v_mfma_f32_16x16x32_bf16 v[244:247], v[36:39], a[36:39], v[244:247]
    v_mfma_f32_16x16x32_bf16 v[248:251], v[40:43], a[36:39], v[248:251]
    v_mfma_f32_16x16x32_bf16 v[252:255], v[44:47], a[36:39], v[252:255]
    s_waitcnt vmcnt(11)
    v_mfma_f32_16x16x32_bf16 v[240:243], v[48:51], a[40:43], v[240:243]
    s_add_u32 s76, s101, s77
    buffer_load_dwordx4 a[24:27], v4, s[56:59], s76 offen offset:0 sc1
    v_mfma_f32_16x16x32_bf16 v[244:247], v[52:55], a[40:43], v[244:247]
    ds_write_b128 v232, a[224:227] offset:8192
    ds_write_b128 v232, a[228:231] offset:9216
    v_mfma_f32_16x16x32_bf16 v[248:251], v[56:59], a[40:43], v[248:251]
    ds_write_b128 v232, a[232:235] offset:10240
    ds_write_b128 v232, a[236:239] offset:11264
    v_mfma_f32_16x16x32_bf16 v[252:255], v[60:63], a[40:43], v[252:255]
    s_waitcnt vmcnt(11)
    v_mfma_f32_16x16x32_bf16 v[240:243], v[64:67], a[44:47], v[240:243]
    buffer_load_dwordx4 a[28:31], v4, s[56:59], s76 offen offset:1024 sc1
    v_mfma_f32_16x16x32_bf16 v[244:247], v[68:71], a[44:47], v[244:247]
    v_mfma_f32_16x16x32_bf16 v[248:251], v[72:75], a[44:47], v[248:251]
    v_mfma_f32_16x16x32_bf16 v[252:255], v[76:79], a[44:47], v[252:255]
    s_waitcnt vmcnt(11)
    v_mfma_f32_16x16x32_bf16 v[240:243], v[80:83], a[48:51], v[240:243]
    s_add_u32 s77, s88, 2
    s_and_b32 s77, s77, 3
    s_add_u32 s77, s77, 4
    s_lshl_b32 s77, s77, 15
    s_add_u32 s76, s98, s77
    buffer_load_dwordx4 a[32:35], v4, s[56:59], s76 offen offset:0 sc1
    v_mfma_f32_16x16x32_bf16 v[244:247], v[84:87], a[48:51], v[244:247]
    v_mfma_f32_16x16x32_bf16 v[248:251], v[88:91], a[48:51], v[248:251]
    v_mfma_f32_16x16x32_bf16 v[252:255], v[92:95], a[48:51], v[252:255]
    s_waitcnt vmcnt(11)
    v_mfma_f32_16x16x32_bf16 v[240:243], v[96:99], a[52:55], v[240:243]
    buffer_load_dwordx4 a[36:39], v4, s[56:59], s76 offen offset:1024 sc1
    v_mfma_f32_16x16x32_bf16 v[244:247], v[100:103], a[52:55], v[244:247]
    v_mfma_f32_16x16x32_bf16 v[248:251], v[104:107], a[52:55], v[248:251]
    v_mfma_f32_16x16x32_bf16 v[252:255], v[108:111], a[52:55], v[252:255]
    s_waitcnt vmcnt(11)
    v_mfma_f32_16x16x32_bf16 v[240:243], v[112:115], a[56:59], v[240:243]
    s_add_u32 s76, s99, s77
    buffer_load_dwordx4 a[40:43], v4, s[56:59], s76 offen offset:0 sc1
    v_mfma_f32_16x16x32_bf16 v[244:247], v[116:119], a[56:59], v[244:247]
    s_waitcnt lgkmcnt(0)
    s_barrier
    v_mfma_f32_16x16x32_bf16 v[248:251], v[120:123], a[56:59], v[248:251]
    ds_read_b128 v[144:147], v233 offset:0
    ds_read_b128 v[148:151], v233 offset:1024
    v_mfma_f32_16x16x32_bf16 v[252:255], v[124:127], a[56:59], v[252:255]
    ds_read_b128 v[152:155], v233 offset:2048
    ds_read_b128 v[156:159], v233 offset:3072
    s_waitcnt vmcnt(11)
    v_mfma_f32_16x16x32_bf16 v[240:243], v[128:131], a[60:63], v[240:243]
    buffer_load_dwordx4 a[44:47], v4, s[56:59], s76 offen offset:1024 sc1
    v_mfma_f32_16x16x32_bf16 v[244:247], v[132:135], a[60:63], v[244:247]
    ds_read_b128 v[160:163], v234 offset:0
    ds_read_b128 v[164:167], v234 offset:1024
    v_mfma_f32_16x16x32_bf16 v[248:251], v[136:139], a[60:63], v[248:251]
    ds_read_b128 v[168:171], v234 offset:2048
    ds_read_b128 v[172:175], v234 offset:3072
    v_mfma_f32_16x16x32_bf16 v[252:255], v[140:143], a[60:63], v[252:255]
    ds_read_b128 v[176:179], v235 offset:0
    ds_read_b128 v[180:183], v235 offset:1024
    s_waitcnt vmcnt(11)
    v_mfma_f32_16x16x32_bf16 a[224:227], v[16:19], a[0:3], 0
    s_add_u32 s76, s100, s77
    buffer_load_dwordx4 a[48:51], v4, s[56:59], s76 offen offset:0 sc1
    v_mfma_f32_16x16x32_bf16 a[228:231], v[20:23], a[0:3], 0
    ds_read_b128 v[184:187], v235 offset:2048
    ds_read_b128 v[188:191], v235 offset:3072
    v_mfma_f32_16x16x32_bf16 a[232:235], v[24:27], a[0:3], 0
    s_waitcnt lgkmcnt(4)
    v_add_f32 v144, v144, v160
    v_mfma_f32_16x16x32_bf16 a[236:239], v[28:31], a[0:3], 0
    v_add_f32 v145, v145, v161
    v_add_f32 v146, v146, v162
    s_waitcnt vmcnt(11)
    v_mfma_f32_16x16x32_bf16 a[224:227], v[32:35], a[4:7], a[224:227]
    buffer_load_dwordx4 a[52:55], v4, s[56:59], s76 offen offset:1024 sc1
    v_mfma_f32_16x16x32_bf16 a[228:231], v[36:39], a[4:7], a[228:231]
    v_add_f32 v147, v147, v163
    v_add_f32 v148, v148, v164
    v_mfma_f32_16x16x32_bf16 a[232:235], v[40:43], a[4:7], a[232:235]
    v_add_f32 v149, v149, v165
    v_add_f32 v150, v150, v166
    v_mfma_f32_16x16x32_bf16 a[236:239], v[44:47], a[4:7], a[236:239]
    v_add_f32 v151, v151, v167
    v_add_f32 v152, v152, v168
    s_waitcnt vmcnt(11)
    v_mfma_f32_16x16x32_bf16 a[224:227], v[48:51], a[8:11], a[224:227]
    s_add_u32 s76, s101, s77
    buffer_load_dwordx4 a[56:59], v4, s[56:59], s76 offen offset:0 sc1
    v_mfma_f32_16x16x32_bf16 a[228:231], v[52:55], a[8:11], a[228:231]
    v_add_f32 v153, v153, v169
    v_add_f32 v154, v154, v170
    v_mfma_f32_16x16x32_bf16 a[232:235], v[56:59], a[8:11], a[232:235]
    v_add_f32 v155, v155, v171
    v_add_f32 v156, v156, v172
    v_mfma_f32_16x16x32_bf16 a[236:239], v[60:63], a[8:11], a[236:239]
    v_add_f32 v157, v157, v173
    v_add_f32 v158, v158, v174
    s_waitcnt vmcnt(11)
    v_mfma_f32_16x16x32_bf16 a[224:227], v[64:67], a[12:15], a[224:227]
    buffer_load_dwordx4 a[60:63], v4, s[56:59], s76 offen offset:1024 sc1
    v_mfma_f32_16x16x32_bf16 a[228:231], v[68:71], a[12:15], a[228:231]
    v_add_f32 v159, v159, v175
    s_waitcnt lgkmcnt(0)
    v_mfma_f32_16x16x32_bf16 a[232:235], v[72:75], a[12:15], a[232:235]
    v_add_f32 v144, v144, v176
    v_add_f32 v145, v145, v177
    v_mfma_f32_16x16x32_bf16 a[236:239], v[76:79], a[12:15], a[236:239]
    v_add_f32 v146, v146, v178
    v_add_f32 v147, v147, v179
    s_waitcnt vmcnt(11)
    v_mfma_f32_16x16x32_bf16 a[224:227], v[80:83], a[16:19], a[224:227]
    s_add_u32 s77, s88, 3
    s_and_b32 s77, s77, 3
    s_add_u32 s77, s77, 4
    s_lshl_b32 s77, s77, 15
    s_add_u32 s76, s98, s77
    buffer_load_dwordx4 a[0:3], v4, s[56:59], s76 offen offset:0 sc1
    v_mfma_f32_16x16x32_bf16 a[228:231], v[84:87], a[16:19], a[228:231]
    v_add_f32 v148, v148, v180
    v_add_f32 v149, v149, v181
    v_mfma_f32_16x16x32_bf16 a[232:235], v[88:91], a[16:19], a[232:235]
    v_add_f32 v150, v150, v182
    v_add_f32 v151, v151, v183
    v_mfma_f32_16x16x32_bf16 a[236:239], v[92:95], a[16:19], a[236:239]
    v_add_f32 v152, v152, v184
    v_add_f32 v153, v153, v185
    s_waitcnt vmcnt(11)
    v_mfma_f32_16x16x32_bf16 a[224:227], v[96:99], a[20:23], a[224:227]
    buffer_load_dwordx4 a[4:7], v4, s[56:59], s76 offen offset:1024 sc1
    v_mfma_f32_16x16x32_bf16 a[228:231], v[100:103], a[20:23], a[228:231]
    v_add_f32 v154, v154, v186
    v_add_f32 v155, v155, v187
    v_mfma_f32_16x16x32_bf16 a[232:235], v[104:107], a[20:23], a[232:235]
    v_add_f32 v156, v156, v188
    v_add_f32 v157, v157, v189
    v_mfma_f32_16x16x32_bf16 a[236:239], v[108:111], a[20:23], a[236:239]
    v_add_f32 v158, v158, v190
    v_add_f32 v159, v159, v191
    s_waitcnt vmcnt(11)
    v_mfma_f32_16x16x32_bf16 a[224:227], v[112:115], a[24:27], a[224:227]
    s_add_u32 s76, s99, s77
    buffer_load_dwordx4 a[8:11], v4, s[56:59], s76 offen offset:0 sc1
    v_mfma_f32_16x16x32_bf16 a[228:231], v[116:119], a[24:27], a[228:231]
    v_add_f32 v144, v144, v240
    v_add_f32 v145, v145, v241
    v_mfma_f32_16x16x32_bf16 a[232:235], v[120:123], a[24:27], a[232:235]
    v_add_f32 v146, v146, v242
    v_add_f32 v147, v147, v243
    v_mfma_f32_16x16x32_bf16 a[236:239], v[124:127], a[24:27], a[236:239]
    v_add_f32 v148, v148, v244
    v_add_f32 v149, v149, v245
    s_waitcnt vmcnt(11)
    v_mfma_f32_16x16x32_bf16 a[224:227], v[128:131], a[28:31], a[224:227]
    buffer_load_dwordx4 a[12:15], v4, s[56:59], s76 offen offset:1024 sc1
    v_mfma_f32_16x16x32_bf16 a[228:231], v[132:135], a[28:31], a[228:231]
    v_add_f32 v150, v150, v246
    v_add_f32 v151, v151, v247
    v_mfma_f32_16x16x32_bf16 a[232:235], v[136:139], a[28:31], a[232:235]
    v_add_f32 v152, v152, v248
    v_add_f32 v153, v153, v249
    v_mfma_f32_16x16x32_bf16 a[236:239], v[140:143], a[28:31], a[236:239]
    v_add_f32 v154, v154, v250
    v_add_f32 v155, v155, v251
    s_waitcnt vmcnt(11)
    v_mfma_f32_16x16x32_bf16 a[240:243], v[16:19], a[32:35], 0
    s_add_u32 s76, s100, s77
    buffer_load_dwordx4 a[16:19], v4, s[56:59], s76 offen offset:0 sc1
    v_mfma_f32_16x16x32_bf16 a[244:247], v[20:23], a[32:35], 0
    v_add_f32 v156, v156, v252
    v_add_f32 v157, v157, v253
    v_mfma_f32_16x16x32_bf16 a[248:251], v[24:27], a[32:35], 0
    v_add_f32 v158, v158, v254
    v_add_f32 v159, v159, v255
    v_mfma_f32_16x16x32_bf16 a[252:255], v[28:31], a[32:35], 0
    v_cvt_pk_bf16_f32 v200, v144, v148
    v_cvt_pk_bf16_f32 v201, v152, v156
    s_waitcnt vmcnt(11)
    v_mfma_f32_16x16x32_bf16 a[240:243], v[32:35], a[36:39], a[240:243]
    buffer_load_dwordx4 a[20:23], v4, s[56:59], s76 offen offset:1024 sc1
    v_mfma_f32_16x16x32_bf16 a[244:247], v[36:39], a[36:39], a[244:247]
    v_cvt_pk_bf16_f32 v202, v145, v149
    v_cvt_pk_bf16_f32 v203, v153, v157
    v_mfma_f32_16x16x32_bf16 a[248:251], v[40:43], a[36:39], a[248:251]
    v_cvt_pk_bf16_f32 v204, v146, v150
    v_cvt_pk_bf16_f32 v205, v154, v158
    v_mfma_f32_16x16x32_bf16 a[252:255], v[44:47], a[36:39], a[252:255]
    v_cvt_pk_bf16_f32 v206, v147, v151
    v_cvt_pk_bf16_f32 v207, v155, v159
    s_waitcnt vmcnt(11)
    v_mfma_f32_16x16x32_bf16 a[240:243], v[48:51], a[40:43], a[240:243]
    s_add_u32 s76, s101, s77
    buffer_load_dwordx4 a[24:27], v4, s[56:59], s76 offen offset:0 sc1
    v_mfma_f32_16x16x32_bf16 a[244:247], v[52:55], a[40:43], a[244:247]
    ds_write_b128 v232, a[224:227] offset:20480
    ds_write_b128 v232, a[228:231] offset:21504
    v_mfma_f32_16x16x32_bf16 a[248:251], v[56:59], a[40:43], a[248:251]
    ds_write_b128 v232, a[232:235] offset:22528
    ds_write_b128 v232, a[236:239] offset:23552
    v_mfma_f32_16x16x32_bf16 a[252:255], v[60:63], a[40:43], a[252:255]
    s_waitcnt vmcnt(11)
    buffer_store_dwordx4 v[200:203], v4, s[56:59], s27 offen sc1
    buffer_store_dwordx4 v[204:207], v4, s[56:59], s27 offen offset:1024 sc1
    s_add_u32 s27, s27, 458752
    v_mfma_f32_16x16x32_bf16 a[240:243], v[64:67], a[44:47], a[240:243]
    buffer_load_dwordx4 a[28:31], v4, s[56:59], s76 offen offset:1024 sc1
    v_mfma_f32_16x16x32_bf16 a[244:247], v[68:71], a[44:47], a[244:247]
    v_mfma_f32_16x16x32_bf16 a[248:251], v[72:75], a[44:47], a[248:251]
    v_mfma_f32_16x16x32_bf16 a[252:255], v[76:79], a[44:47], a[252:255]
    s_waitcnt vmcnt(13)
    v_mfma_f32_16x16x32_bf16 a[240:243], v[80:83], a[48:51], a[240:243]
    s_add_u32 s77, s88, 4
    s_and_b32 s77, s77, 3
    s_add_u32 s77, s77, 4
    s_lshl_b32 s77, s77, 15
    s_add_u32 s76, s98, s77
    buffer_load_dwordx4 a[32:35], v4, s[56:59], s76 offen offset:0 sc1
    v_mfma_f32_16x16x32_bf16 a[244:247], v[84:87], a[48:51], a[244:247]
    v_mfma_f32_16x16x32_bf16 a[248:251], v[88:91], a[48:51], a[248:251]
    v_mfma_f32_16x16x32_bf16 a[252:255], v[92:95], a[48:51], a[252:255]
    s_waitcnt vmcnt(13)
    v_mfma_f32_16x16x32_bf16 a[240:243], v[96:99], a[52:55], a[240:243]
    buffer_load_dwordx4 a[36:39], v4, s[56:59], s76 offen offset:1024 sc1
    v_mfma_f32_16x16x32_bf16 a[244:247], v[100:103], a[52:55], a[244:247]
    v_mfma_f32_16x16x32_bf16 a[248:251], v[104:107], a[52:55], a[248:251]
    v_mfma_f32_16x16x32_bf16 a[252:255], v[108:111], a[52:55], a[252:255]
    s_waitcnt vmcnt(13)
    v_mfma_f32_16x16x32_bf16 a[240:243], v[112:115], a[56:59], a[240:243]
    s_add_u32 s76, s99, s77
    buffer_load_dwordx4 a[40:43], v4, s[56:59], s76 offen offset:0 sc1
    v_mfma_f32_16x16x32_bf16 a[244:247], v[116:119], a[56:59], a[244:247]
    v_mfma_f32_16x16x32_bf16 a[248:251], v[120:123], a[56:59], a[248:251]
    v_mfma_f32_16x16x32_bf16 a[252:255], v[124:127], a[56:59], a[252:255]
    s_waitcnt vmcnt(13)
    v_mfma_f32_16x16x32_bf16 a[240:243], v[128:131], a[60:63], a[240:243]
    buffer_load_dwordx4 a[44:47], v4, s[56:59], s76 offen offset:1024 sc1
    v_mfma_f32_16x16x32_bf16 a[244:247], v[132:135], a[60:63], a[244:247]
    v_mfma_f32_16x16x32_bf16 a[248:251], v[136:139], a[60:63], a[248:251]
    v_mfma_f32_16x16x32_bf16 a[252:255], v[140:143], a[60:63], a[252:255]
    s_waitcnt vmcnt(13)
    v_mfma_f32_16x16x32_bf16 a[224:227], v[16:19], a[0:3], 0
    s_add_u32 s76, s100, s77
    buffer_load_dwordx4 a[48:51], v4, s[56:59], s76 offen offset:0 sc1
    v_mfma_f32_16x16x32_bf16 a[228:231], v[20:23], a[0:3], 0
    v_mfma_f32_16x16x32_bf16 a[232:235], v[24:27], a[0:3], 0
    v_mfma_f32_16x16x32_bf16 a[236:239], v[28:31], a[0:3], 0
    s_waitcnt vmcnt(13)
    v_mfma_f32_16x16x32_bf16 a[224:227], v[32:35], a[4:7], a[224:227]
    buffer_load_dwordx4 a[52:55], v4, s[56:59], s76 offen offset:1024 sc1
    v_mfma_f32_16x16x32_bf16 a[228:231], v[36:39], a[4:7], a[228:231]
    v_mfma_f32_16x16x32_bf16 a[232:235], v[40:43], a[4:7], a[232:235]
    v_mfma_f32_16x16x32_bf16 a[236:239], v[44:47], a[4:7], a[236:239]
    s_waitcnt vmcnt(13)
    v_mfma_f32_16x16x32_bf16 a[224:227], v[48:51], a[8:11], a[224:227]
    s_add_u32 s76, s101, s77
    buffer_load_dwordx4 a[56:59], v4, s[56:59], s76 offen offset:0 sc1
    v_mfma_f32_16x16x32_bf16 a[228:231], v[52:55], a[8:11], a[228:231]
    ds_write_b128 v232, a[240:243] offset:24576
    ds_write_b128 v232, a[244:247] offset:25600
    v_mfma_f32_16x16x32_bf16 a[232:235], v[56:59], a[8:11], a[232:235]
    ds_write_b128 v232, a[248:251] offset:26624
    ds_write_b128 v232, a[252:255] offset:27648
    v_mfma_f32_16x16x32_bf16 a[236:239], v[60:63], a[8:11], a[236:239]
    s_waitcnt vmcnt(13)
    v_mfma_f32_16x16x32_bf16 a[224:227], v[64:67], a[12:15], a[224:227]
    buffer_load_dwordx4 a[60:63], v4, s[56:59], s76 offen offset:1024 sc1
    v_mfma_f32_16x16x32_bf16 a[228:231], v[68:71], a[12:15], a[228:231]
    v_mfma_f32_16x16x32_bf16 a[232:235], v[72:75], a[12:15], a[232:235]
    v_mfma_f32_16x16x32_bf16 a[236:239], v[76:79], a[12:15], a[236:239]
    s_waitcnt vmcnt(13)
    v_mfma_f32_16x16x32_bf16 a[224:227], v[80:83], a[16:19], a[224:227]
    v_mfma_f32_16x16x32_bf16 a[228:231], v[84:87], a[16:19], a[228:231]
    v_mfma_f32_16x16x32_bf16 a[232:235], v[88:91], a[16:19], a[232:235]
    v_mfma_f32_16x16x32_bf16 a[236:239], v[92:95], a[16:19], a[236:239]
    s_waitcnt vmcnt(12)
    v_mfma_f32_16x16x32_bf16 a[224:227], v[96:99], a[20:23], a[224:227]
    v_mfma_f32_16x16x32_bf16 a[228:231], v[100:103], a[20:23], a[228:231]
    v_mfma_f32_16x16x32_bf16 a[232:235], v[104:107], a[20:23], a[232:235]
    v_mfma_f32_16x16x32_bf16 a[236:239], v[108:111], a[20:23], a[236:239]
    s_waitcnt vmcnt(11)
    v_mfma_f32_16x16x32_bf16 a[224:227], v[112:115], a[24:27], a[224:227]
    v_mfma_f32_16x16x32_bf16 a[228:231], v[116:119], a[24:27], a[228:231]
    v_mfma_f32_16x16x32_bf16 a[232:235], v[120:123], a[24:27], a[232:235]
    v_mfma_f32_16x16x32_bf16 a[236:239], v[124:127], a[24:27], a[236:239]
    s_waitcnt vmcnt(8)
    s_cmp_eq_u32 s4, 0
    s_cselect_b32 s70, 0, 0x7f000000
    v_mov_b32 v7, s69
    v_mov_b32 v239, s70
    s_barrier
    s_mov_b64 exec, 1
    buffer_store_dword v7, v239, s[56:59], s86 offen sc1
    s_mov_b64 exec, -1
    v_mfma_f32_16x16x32_bf16 a[224:227], v[128:131], a[28:31], a[224:227]
    s_mul_i32 s91, s61, 1376256
    s_add_u32 s91, s91, s90
    s_add_u32 m0, s74, 0
    s_add_u32 s76, s91, 0x0
    buffer_load_dwordx4 v10, s[48:51], s76 offen  lds
    s_add_u32 m0, s74, 1024
    s_add_u32 s76, s91, 0x1c000
    buffer_load_dwordx4 v11, s[48:51], s76 offen  lds
    s_add_u32 m0, s74, 2048
    s_add_u32 s76, s91, 0x38000
    buffer_load_dwordx4 v10, s[48:51], s76 offen  lds
    s_add_u32 m0, s74, 3072
    s_add_u32 s76, s91, 0x54000
    buffer_load_dwordx4 v11, s[48:51], s76 offen  lds
    v_mfma_f32_16x16x32_bf16 a[228:231], v[132:135], a[28:31], a[228:231]
    v_mfma_f32_16x16x32_bf16 a[232:235], v[136:139], a[28:31], a[232:235]
    v_mfma_f32_16x16x32_bf16 a[236:239], v[140:143], a[28:31], a[236:239]
    s_waitcnt vmcnt(12)
    v_mfma_f32_16x16x32_bf16 v[240:243], v[16:19], a[32:35], 0
    s_mul_i32 s91, s61, 1376256
    s_add_u32 s91, s91, s90
    s_add_u32 m0, s74, 4096
    s_add_u32 s76, s91, 0xe000
    buffer_load_dwordx4 v10, s[48:51], s76 offen  lds
    v_mfma_f32_16x16x32_bf16 v[244:247], v[20:23], a[32:35], 0
    v_mfma_f32_16x16x32_bf16 v[248:251], v[24:27], a[32:35], 0
    v_mfma_f32_16x16x32_bf16 v[252:255], v[28:31], a[32:35], 0
    s_waitcnt vmcnt(12)
    v_mfma_f32_16x16x32_bf16 v[240:243], v[32:35], a[36:39], v[240:243]
    s_add_u32 m0, s74, 5120
    s_add_u32 s76, s91, 0x2a000
    buffer_load_dwordx4 v11, s[48:51], s76 offen  lds
    v_mfma_f32_16x16x32_bf16 v[244:247], v[36:39], a[36:39], v[244:247]
    v_mfma_f32_16x16x32_bf16 v[248:251], v[40:43], a[36:39], v[248:251]
    v_mfma_f32_16x16x32_bf16 v[252:255], v[44:47], a[36:39], v[252:255]
    s_waitcnt vmcnt(12)
    v_mfma_f32_16x16x32_bf16 v[240:243], v[48:51], a[40:43], v[240:243]
    s_add_u32 m0, s74, 6144
    s_add_u32 s76, s91, 0x46000
    buffer_load_dwordx4 v10, s[48:51], s76 offen  lds
    ds_write_b128 v232, a[224:227] offset:28672
    v_mfma_f32_16x16x32_bf16 v[244:247], v[52:55], a[40:43], v[244:247]
    ds_write_b128 v232, a[228:231] offset:29696
    v_mfma_f32_16x16x32_bf16 v[248:251], v[56:59], a[40:43], v[248:251]
    ds_write_b128 v232, a[232:235] offset:30720
    v_mfma_f32_16x16x32_bf16 v[252:255], v[60:63], a[40:43], v[252:255]
    ds_write_b128 v232, a[236:239] offset:31744
    s_waitcnt vmcnt(12)
    v_mfma_f32_16x16x32_bf16 v[240:243], v[64:67], a[44:47], v[240:243]
    s_add_u32 m0, s74, 7168
    s_add_u32 s76, s91, 0x62000
    buffer_load_dwordx4 v11, s[48:51], s76 offen  lds
    s_waitcnt lgkmcnt(0)
    s_barrier
    ds_read_b128 v[144:147], v233 offset:20480
    v_mfma_f32_16x16x32_bf16 v[244:247], v[68:71], a[44:47], v[244:247]
    ds_read_b128 v[148:151], v233 offset:21504
    ds_read_b128 v[152:155], v233 offset:22528
    ds_read_b128 v[156:159], v233 offset:23552
    v_mfma_f32_16x16x32_bf16 v[248:251], v[72:75], a[44:47], v[248:251]
    ds_read_b128 v[160:163], v234 offset:20480
    ds_read_b128 v[164:167], v234 offset:21504
    ds_read_b128 v[168:171], v234 offset:22528
    v_mfma_f32_16x16x32_bf16 v[252:255], v[76:79], a[44:47], v[252:255]
    ds_read_b128 v[172:175], v234 offset:23552
    ds_read_b128 v[176:179], v235 offset:20480
    ds_read_b128 v[180:183], v235 offset:21504
    s_waitcnt vmcnt(12)
    v_mfma_f32_16x16x32_bf16 v[240:243], v[80:83], a[48:51], v[240:243]
    s_mul_i32 s91, s61, 1376256
    s_add_u32 s91, s91, s90
    s_add_u32 m0, s74, 8192
    s_add_u32 s76, s91, 0x70000
    buffer_load_dwordx4 v10, s[48:51], s76 offen  lds
    ds_read_b128 v[184:187], v235 offset:22528
    ds_read_b128 v[188:191], v235 offset:23552
    s_waitcnt lgkmcnt(4)
    v_mfma_f32_16x16x32_bf16 v[244:247], v[84:87], a[48:51], v[244:247]
    v_add_f32 v144, v144, v160
    v_add_f32 v145, v145, v161
    v_add_f32 v146, v146, v162
    v_mfma_f32_16x16x32_bf16 v[248:251], v[88:91], a[48:51], v[248:251]
    v_add_f32 v147, v147, v163
    v_add_f32 v148, v148, v164
    v_add_f32 v149, v149, v165
    v_mfma_f32_16x16x32_bf16 v[252:255], v[92:95], a[48:51], v[252:255]
    v_add_f32 v150, v150, v166
    v_add_f32 v151, v151, v167
    v_add_f32 v152, v152, v168
    s_waitcnt vmcnt(12)
    v_mfma_f32_16x16x32_bf16 v[240:243], v[96:99], a[52:55], v[240:243]
    s_add_u32 m0, s74, 9216
    s_add_u32 s76, s91, 0x8c000
    buffer_load_dwordx4 v11, s[48:51], s76 offen  lds
    v_add_f32 v153, v153, v169
    v_add_f32 v154, v154, v170
    v_add_f32 v155, v155, v171
    v_mfma_f32_16x16x32_bf16 v[244:247], v[100:103], a[52:55], v[244:247]
    v_add_f32 v156, v156, v172
    v_add_f32 v157, v157, v173
    v_add_f32 v158, v158, v174
    v_mfma_f32_16x16x32_bf16 v[248:251], v[104:107], a[52:55], v[248:251]
    v_add_f32 v159, v159, v175
    s_waitcnt lgkmcnt(0)
    v_add_f32 v144, v144, v176
    v_mfma_f32_16x16x32_bf16 v[252:255], v[108:111], a[52:55], v[252:255]
    v_add_f32 v145, v145, v177
    v_add_f32 v146, v146, v178
    v_add_f32 v147, v147, v179
    s_waitcnt vmcnt(12)
    v_mfma_f32_16x16x32_bf16 v[240:243], v[112:115], a[56:59], v[240:243]
    v_add_f32 v148, v148, v180
    v_add_f32 v149, v149, v181
    v_add_f32 v150, v150, v182
    v_mfma_f32_16x16x32_bf16 v[244:247], v[116:119], a[56:59], v[244:247]
    v_add_f32 v151, v151, v183
    v_add_f32 v152, v152, v184
    v_add_f32 v153, v153, v185
    v_mfma_f32_16x16x32_bf16 v[248:251], v[120:123], a[56:59], v[248:251]
    v_add_f32 v154, v154, v186
    v_add_f32 v155, v155, v187
    v_add_f32 v156, v156, v188
    v_mfma_f32_16x16x32_bf16 v[252:255], v[124:127], a[56:59], v[252:255]
    v_add_f32 v157, v157, v189
    v_add_f32 v158, v158, v190
    v_add_f32 v159, v159, v191
    s_waitcnt vmcnt(11)
    v_mfma_f32_16x16x32_bf16 v[240:243], v[128:131], a[60:63], v[240:243]
    v_mfma_f32_16x16x32_bf16 v[244:247], v[132:135], a[60:63], v[244:247]
    v_mfma_f32_16x16x32_bf16 v[248:251], v[136:139], a[60:63], v[248:251]
    v_mfma_f32_16x16x32_bf16 v[252:255], v[140:143], a[60:63], v[252:255]
    s_nop 4
    v_pk_add_f32 v[240:241], v[240:241], v[144:145]
    v_pk_add_f32 v[242:243], v[242:243], v[146:147]
    v_pk_add_f32 v[244:245], v[244:245], v[148:149]
    v_pk_add_f32 v[246:247], v[246:247], v[150:151]
    v_pk_add_f32 v[248:249], v[248:249], v[152:153]
    v_pk_add_f32 v[250:251], v[250:251], v[154:155]
    v_pk_add_f32 v[252:253], v[252:253], v[156:157]
    v_pk_add_f32 v[254:255], v[254:255], v[158:159]
    v_cvt_pk_bf16_f32 v192, v240, v244
    v_cvt_pk_bf16_f32 v193, v248, v252
    v_cvt_pk_bf16_f32 v194, v241, v245
    v_cvt_pk_bf16_f32 v195, v249, v253
    v_cvt_pk_bf16_f32 v196, v242, v246
    v_cvt_pk_bf16_f32 v197, v250, v254
    v_cvt_pk_bf16_f32 v198, v243, v247
    v_cvt_pk_bf16_f32 v199, v251, v255
    buffer_store_dwordx4 v[192:195], v4, s[56:59], s27 offen sc1
    buffer_store_dwordx4 v[196:199], v4, s[56:59], s27 offen offset:1024 sc1
    s_add_u32 m0, s74, 10240
    s_add_u32 s76, s91, 0xa8000
    buffer_load_dwordx4 v10, s[48:51], s76 offen  lds
    s_add_u32 m0, s74, 11264
    s_add_u32 s76, s91, 0xc4000
    buffer_load_dwordx4 v11, s[48:51], s76 offen  lds
    s_mul_i32 s91, s61, 1376256
    s_add_u32 s91, s91, s90
    s_add_u32 m0, s74, 12288
    s_add_u32 s76, s91, 0x7e000
    buffer_load_dwordx4 v10, s[48:51], s76 offen  lds
    s_mul_i32 s70, s67, 64
    s_mul_i32 s71, s4, 12
    s_add_u32 s70, s70, s71
    s_lshl_b32 s70, s70, 10
    s_add_u32 s70, s70, 0x100000
    s_mul_i32 s71, s61, 6144
    s_add_u32 s71, s71, 0
    s_add_u32 s36, s70, s71
    s_mul_i32 s71, s61, -6144
    s_add_u32 s71, s71, 6144
    s_add_u32 s37, s70, s71
    s_lshl_b32 s70, s61, 1
    s_add_u32 s41, s70, 0
    s_xor_b32 s40, s41, 1
    s_lshl_b32 s41, s41, 2
    s_lshl_b32 s40, s40, 2
    s_add_u32 s3, s4, s68
    s_mul_i32 s70, s61, 56
    s_add_u32 s70, s70, s68
    s_lshl_b32 s70, s70, 1
    s_add_u32 s70, s70, s67
    s_lshl_b32 s70, s70, 2
    s_add_u32 s70, s70, s4
    s_xor_b32 s71, s70, 4
    s_lshl_b32 s94, s70, 12
    s_add_u32 s94, s94, 0x400000
    s_lshl_b32 s95, s71, 12
    s_add_u32 s95, s95, 0x400000
    s_mul_i32 s70, s5, 37
    s_add_u32 s70, s70, 11
    s_add_u32 s71, s70, 0
    s_and_b32 s71, s71, 0xff
    v_mov_b32 v224, s71
    s_mov_b32 s43, s71
    s_add_u32 s71, s70, 64
    s_and_b32 s71, s71, 0xff
    v_mov_b32 v225, s71
    s_lshl_b32 s71, s71, 8
    s_or_b32 s43, s43, s71
    s_add_u32 s71, s70, 128
    s_and_b32 s71, s71, 0xff
    v_mov_b32 v226, s71
    s_lshl_b32 s71, s71, 16
    s_or_b32 s43, s43, s71
    s_add_u32 s71, s70, 192
    s_and_b32 s71, s71, 0xff
    v_mov_b32 v227, s71
    s_lshl_b32 s71, s71, 24
    s_or_b32 s43, s43, s71
    v_mov_b32 v228, 0xff
    v_mov_b32 v229, 0x0c0c0400
    v_mov_b32 v230, 0x04000c0c
    s_and_b32 s71, s3, 3
    s_add_u32 s71, s71, s41
    s_mul_i32 s71, s71, 114688
    s_lshl_b32 s70, s68, 7
    s_add_u32 s96, s71, s70
    v_mul_u32_u24 v5, 7168, v3
    v_and_b32 v6, 1, v2
    v_lshl_add_u32 v5, v6, 5, v5
    v_lshrrev_b32 v6, 1, v2
    v_lshl_add_u32 v5, v6, 4, v5
    s_waitcnt vmcnt(3)
    s_cmp_eq_u32 s4, 0
    s_cselect_b32 s70, 0, 0x7f000000
    v_mov_b32 v7, s69
    v_mov_b32 v239, s70
    s_barrier
    s_mov_b64 exec, 1
    buffer_store_dword v7, v239, s[56:59], s26 offen sc1
    s_mov_b64 exec, -1
    s_add_u32 m0, s74, 13312
    s_add_u32 s76, s91, 0x9a000
    buffer_load_dwordx4 v11, s[48:51], s76 offen  lds
    s_add_u32 m0, s74, 14336
    s_add_u32 s76, s91, 0xb6000
    buffer_load_dwordx4 v10, s[48:51], s76 offen  lds
    s_add_u32 m0, s74, 15360
    s_add_u32 s76, s91, 0xd2000
    buffer_load_dwordx4 v11, s[48:51], s76 offen  lds
    s_mul_i32 s91, s61, 1376256
    s_add_u32 s91, s91, s90
    s_add_u32 m0, s74, 16384
    s_add_u32 s76, s91, 0xe0000
    buffer_load_dwordx4 v10, s[48:51], s76 offen  lds
    s_add_u32 m0, s74, 17408
    s_add_u32 s76, s91, 0xfc000
    buffer_load_dwordx4 v11, s[48:51], s76 offen  lds
    s_add_u32 m0, s74, 18432
    s_add_u32 s76, s91, 0x118000
    buffer_load_dwordx4 v10, s[48:51], s76 offen  lds
    s_add_u32 m0, s74, 19456
    s_add_u32 s76, s91, 0x134000
    buffer_load_dwordx4 v11, s[48:51], s76 offen  lds
    ds_read_b64_tr_b16 a[64:65], v12 offset:0
    ds_read_b64_tr_b16 a[66:67], v12 offset:512
    ds_read_b64_tr_b16 a[68:69], v13 offset:0
    ds_read_b64_tr_b16 a[70:71], v13 offset:512
    ds_read_b64_tr_b16 a[72:73], v14 offset:0
    ds_read_b64_tr_b16 a[74:75], v14 offset:512
    ds_read_b64_tr_b16 a[76:77], v15 offset:0
    ds_read_b64_tr_b16 a[78:79], v15 offset:512
    s_waitcnt lgkmcnt(0)
    ds_read_b64_tr_b16 a[80:81], v12 offset:4096
    ds_read_b64_tr_b16 a[82:83], v12 offset:4608
    ds_read_b64_tr_b16 a[84:85], v13 offset:4096
    ds_read_b64_tr_b16 a[86:87], v13 offset:4608
    ds_read_b64_tr_b16 a[88:89], v14 offset:4096
    ds_read_b64_tr_b16 a[90:91], v14 offset:4608
    ds_read_b64_tr_b16 a[92:93], v15 offset:4096
    ds_read_b64_tr_b16 a[94:95], v15 offset:4608
    s_mul_i32 s91, s61, 1376256
    s_add_u32 s91, s91, s90
    s_add_u32 m0, s74, 0
    s_add_u32 s76, s91, 0xee000
    buffer_load_dwordx4 v10, s[48:51], s76 offen  lds
    s_add_u32 m0, s74, 1024
    s_add_u32 s76, s91, 0x10a000
    buffer_load_dwordx4 v11, s[48:51], s76 offen  lds
    s_add_u32 m0, s74, 2048
    s_add_u32 s76, s91, 0x126000
    buffer_load_dwordx4 v10, s[48:51], s76 offen  lds
    s_add_u32 m0, s74, 3072
    s_add_u32 s76, s91, 0x142000
    buffer_load_dwordx4 v11, s[48:51], s76 offen  lds
    s_waitcnt vmcnt(13)
    s_waitcnt lgkmcnt(0)
    ds_read_b64_tr_b16 a[96:97], v12 offset:8192
    ds_read_b64_tr_b16 a[98:99], v12 offset:8704
    ds_read_b64_tr_b16 a[100:101], v13 offset:8192
    ds_read_b64_tr_b16 a[102:103], v13 offset:8704
    ds_read_b64_tr_b16 a[104:105], v14 offset:8192
    ds_read_b64_tr_b16 a[106:107], v14 offset:8704
    ds_read_b64_tr_b16 a[108:109], v15 offset:8192
    ds_read_b64_tr_b16 a[110:111], v15 offset:8704
    s_mul_i32 s91, s61, -1376256
    s_add_u32 s91, s91, s90
    s_add_u32 m0, s74, 4096
    s_add_u32 s76, s91, 0x150000
    buffer_load_dwordx4 v10, s[48:51], s76 offen  lds
    s_add_u32 m0, s74, 5120
    s_add_u32 s76, s91, 0x16c000
    buffer_load_dwordx4 v11, s[48:51], s76 offen  lds
    s_add_u32 m0, s74, 6144
    s_add_u32 s76, s91, 0x188000
    buffer_load_dwordx4 v10, s[48:51], s76 offen  lds
    s_add_u32 m0, s74, 7168
    s_add_u32 s76, s91, 0x1a4000
    buffer_load_dwordx4 v11, s[48:51], s76 offen  lds
    s_waitcnt vmcnt(12)
    s_waitcnt lgkmcnt(0)
    ds_read_b64_tr_b16 a[112:113], v12 offset:12288
    ds_read_b64_tr_b16 a[114:115], v12 offset:12800
    ds_read_b64_tr_b16 a[116:117], v13 offset:12288
    ds_read_b64_tr_b16 a[118:119], v13 offset:12800
    ds_read_b64_tr_b16 a[120:121], v14 offset:12288
    ds_read_b64_tr_b16 a[122:123], v14 offset:12800
    ds_read_b64_tr_b16 a[124:125], v15 offset:12288
    ds_read_b64_tr_b16 a[126:127], v15 offset:12800
    s_waitcnt vmcnt(8)
    s_waitcnt lgkmcnt(0)
    ds_read_b64_tr_b16 a[128:129], v12 offset:16384
    ds_read_b64_tr_b16 a[130:131], v12 offset:16896
    ds_read_b64_tr_b16 a[132:133], v13 offset:16384
    ds_read_b64_tr_b16 a[134:135], v13 offset:16896
    ds_read_b64_tr_b16 a[136:137], v14 offset:16384
    ds_read_b64_tr_b16 a[138:139], v14 offset:16896
    ds_read_b64_tr_b16 a[140:141], v15 offset:16384
    ds_read_b64_tr_b16 a[142:143], v15 offset:16896
    s_mul_i32 s91, s61, -1376256
    s_add_u32 s91, s91, s90
    s_add_u32 m0, s74, 8192
    s_add_u32 s76, s91, 0x15e000
    buffer_load_dwordx4 v10, s[48:51], s76 offen  lds
    s_add_u32 m0, s74, 9216
    s_add_u32 s76, s91, 0x17a000
    buffer_load_dwordx4 v11, s[48:51], s76 offen  lds
    s_add_u32 m0, s74, 10240
    s_add_u32 s76, s91, 0x196000
    buffer_load_dwordx4 v10, s[48:51], s76 offen  lds
    s_add_u32 m0, s74, 11264
    s_add_u32 s76, s91, 0x1b2000
    buffer_load_dwordx4 v11, s[48:51], s76 offen  lds
    s_waitcnt vmcnt(8)
    s_waitcnt lgkmcnt(0)
    ds_read_b64_tr_b16 a[144:145], v12 offset:0
    ds_read_b64_tr_b16 a[146:147], v12 offset:512
    ds_read_b64_tr_b16 a[148:149], v13 offset:0
    ds_read_b64_tr_b16 a[150:151], v13 offset:512
    ds_read_b64_tr_b16 a[152:153], v14 offset:0
    ds_read_b64_tr_b16 a[154:155], v14 offset:512
    ds_read_b64_tr_b16 a[156:157], v15 offset:0
    ds_read_b64_tr_b16 a[158:159], v15 offset:512
    s_mul_i32 s91, s61, -1376256
    s_add_u32 s91, s91, s90
    s_add_u32 m0, s74, 12288
    s_add_u32 s76, s91, 0x1c0000
    buffer_load_dwordx4 v10, s[48:51], s76 offen  lds
    s_add_u32 m0, s74, 13312
    s_add_u32 s76, s91, 0x1dc000
    buffer_load_dwordx4 v11, s[48:51], s76 offen  lds
    s_add_u32 m0, s74, 14336
    s_add_u32 s76, s91, 0x1f8000
    buffer_load_dwordx4 v10, s[48:51], s76 offen  lds
    s_add_u32 m0, s74, 15360
    s_add_u32 s76, s91, 0x214000
    buffer_load_dwordx4 v11, s[48:51], s76 offen  lds
    s_waitcnt vmcnt(8)
    s_waitcnt lgkmcnt(0)
    ds_read_b64_tr_b16 a[160:161], v12 offset:4096
    ds_read_b64_tr_b16 a[162:163], v12 offset:4608
    ds_read_b64_tr_b16 a[164:165], v13 offset:4096
    ds_read_b64_tr_b16 a[166:167], v13 offset:4608
    ds_read_b64_tr_b16 a[168:169], v14 offset:4096
    ds_read_b64_tr_b16 a[170:171], v14 offset:4608
    ds_read_b64_tr_b16 a[172:173], v15 offset:4096
    ds_read_b64_tr_b16 a[174:175], v15 offset:4608
    s_mul_i32 s91, s61, -1376256
    s_add_u32 s91, s91, s90
    s_add_u32 m0, s74, 16384
    s_add_u32 s76, s91, 0x1ce000
    buffer_load_dwordx4 v10, s[48:51], s76 offen  lds
    s_add_u32 m0, s74, 17408
    s_add_u32 s76, s91, 0x1ea000
    buffer_load_dwordx4 v11, s[48:51], s76 offen  lds
    s_add_u32 m0, s74, 18432
    s_add_u32 s76, s91, 0x206000
    buffer_load_dwordx4 v10, s[48:51], s76 offen  lds
    s_add_u32 m0, s74, 19456
    s_add_u32 s76, s91, 0x222000
    buffer_load_dwordx4 v11, s[48:51], s76 offen  lds
    s_waitcnt vmcnt(8)
    s_waitcnt lgkmcnt(0)
    ds_read_b64_tr_b16 a[176:177], v12 offset:8192
    ds_read_b64_tr_b16 a[178:179], v12 offset:8704
    ds_read_b64_tr_b16 a[180:181], v13 offset:8192
    ds_read_b64_tr_b16 a[182:183], v13 offset:8704
    ds_read_b64_tr_b16 a[184:185], v14 offset:8192
    ds_read_b64_tr_b16 a[186:187], v14 offset:8704
    ds_read_b64_tr_b16 a[188:189], v15 offset:8192
    ds_read_b64_tr_b16 a[190:191], v15 offset:8704
    buffer_load_dword v238, v237, s[56:59], s7 offen sc1
    s_mul_i32 s91, s61, -1376256
    s_add_u32 s91, s91, s90
    s_add_u32 m0, s74, 0
    s_add_u32 s76, s91, 0x230000
    buffer_load_dwordx4 v10, s[48:51], s76 offen  lds
    s_add_u32 m0, s74, 1024
    s_add_u32 s76, s91, 0x24c000
    buffer_load_dwordx4 v11, s[48:51], s76 offen  lds
    s_add_u32 m0, s74, 2048
    s_add_u32 s76, s91, 0x268000
    buffer_load_dwordx4 v10, s[48:51], s76 offen  lds
    s_waitcnt vmcnt(8)
    s_waitcnt lgkmcnt(0)
    ds_read_b64_tr_b16 a[192:193], v12 offset:12288
    ds_read_b64_tr_b16 a[194:195], v12 offset:12800
    ds_read_b64_tr_b16 a[196:197], v13 offset:12288
    ds_read_b64_tr_b16 a[198:199], v13 offset:12800
    ds_read_b64_tr_b16 a[200:201], v14 offset:12288
    ds_read_b64_tr_b16 a[202:203], v14 offset:12800
    ds_read_b64_tr_b16 a[204:205], v15 offset:12288
    ds_read_b64_tr_b16 a[206:207], v15 offset:12800
    s_add_u32 m0, s74, 3072
    s_add_u32 s76, s91, 0x284000
    buffer_load_dwordx4 v11, s[48:51], s76 offen  lds
    s_mul_i32 s91, s61, -1376256
    s_add_u32 s91, s91, s90
    s_add_u32 m0, s74, 4096
    s_add_u32 s76, s91, 0x23e000
    buffer_load_dwordx4 v10, s[48:51], s76 offen  lds
    s_add_u32 m0, s74, 5120
    s_add_u32 s76, s91, 0x25a000
    buffer_load_dwordx4 v11, s[48:51], s76 offen  lds
    s_add_u32 m0, s74, 6144
    s_add_u32 s76, s91, 0x276000
    buffer_load_dwordx4 v10, s[48:51], s76 offen  lds
    s_waitcnt vmcnt(8)
    s_waitcnt lgkmcnt(0)
    ds_read_b64_tr_b16 a[208:209], v12 offset:16384
    ds_read_b64_tr_b16 a[210:211], v12 offset:16896
    ds_read_b64_tr_b16 a[212:213], v13 offset:16384
    ds_read_b64_tr_b16 a[214:215], v13 offset:16896
    ds_read_b64_tr_b16 a[216:217], v14 offset:16384
    ds_read_b64_tr_b16 a[218:219], v14 offset:16896
    ds_read_b64_tr_b16 a[220:221], v15 offset:16384
    ds_read_b64_tr_b16 a[222:223], v15 offset:16896
    s_add_u32 m0, s74, 7168
    s_add_u32 s76, s91, 0x292000
    buffer_load_dwordx4 v11, s[48:51], s76 offen  lds
    s_waitcnt vmcnt(4)
    v_cmp_ne_u32 vcc, s69, v238
    s_mov_b32 s75, 0
    s_cbranch_vccz POLLX_10
POLL_9:
    s_sleep 8
    buffer_load_dword v238, v237, s[56:59], s7 offen sc1
    s_add_u32 s75, s75, 1
    s_waitcnt vmcnt(0)
    v_cmp_ne_u32 vcc, s69, v238
    s_cmp_gt_u32 s75, 0x40000
    s_cbranch_scc1 POLLX_10
    s_cbranch_vccnz POLL_9
POLLX_10:
    s_waitcnt lgkmcnt(0)
    ds_read_b64_tr_b16 a[0:1], v12 offset:0
    ds_read_b64_tr_b16 a[2:3], v12 offset:512
    ds_read_b64_tr_b16 a[4:5], v13 offset:0
    ds_read_b64_tr_b16 a[6:7], v13 offset:512
    ds_read_b64_tr_b16 a[8:9], v14 offset:0
    ds_read_b64_tr_b16 a[10:11], v14 offset:512
    ds_read_b64_tr_b16 a[12:13], v15 offset:0
    ds_read_b64_tr_b16 a[14:15], v15 offset:512
    s_add_u32 s42, s3, 1
    s_and_b32 s42, s42, 3
    s_add_u32 s42, s42, s40
    s_mul_i32 s42, s42, 114688
    s_add_u32 s76, s42, s36
    buffer_load_dwordx4 v[16:19], v4, s[56:59], s76 offen offset:0 sc1
    buffer_load_dwordx4 v[20:23], v4, s[56:59], s76 offen offset:1024 sc1
    buffer_load_dwordx4 v[24:27], v4, s[56:59], s76 offen offset:2048 sc1
    buffer_load_dwordx4 v[28:31], v4, s[56:59], s76 offen offset:3072 sc1
    s_add_u32 s76, s76, 4096
    buffer_load_dwordx4 v[32:35], v4, s[56:59], s76 offen offset:0 sc1
    buffer_load_dwordx4 v[36:39], v4, s[56:59], s76 offen offset:1024 sc1
    s_add_u32 s76, s42, s37
    buffer_load_dwordx4 v[40:43], v4, s[56:59], s76 offen offset:0 sc1
    buffer_load_dwordx4 v[44:47], v4, s[56:59], s76 offen offset:1024 sc1
    s_waitcnt vmcnt(8)
    s_waitcnt lgkmcnt(0)
    ds_read_b64_tr_b16 a[16:17], v12 offset:4096
    ds_read_b64_tr_b16 a[18:19], v12 offset:4608
    ds_read_b64_tr_b16 a[20:21], v13 offset:4096
    ds_read_b64_tr_b16 a[22:23], v13 offset:4608
    ds_read_b64_tr_b16 a[24:25], v14 offset:4096
    ds_read_b64_tr_b16 a[26:27], v14 offset:4608
    ds_read_b64_tr_b16 a[28:29], v15 offset:4096
    ds_read_b64_tr_b16 a[30:31], v15 offset:4608
    buffer_load_dwordx4 v[48:51], v4, s[56:59], s76 offen offset:2048 sc1
    buffer_load_dwordx4 v[52:55], v4, s[56:59], s76 offen offset:3072 sc1
    s_add_u32 s76, s76, 4096
    buffer_load_dwordx4 v[56:59], v4, s[56:59], s76 offen offset:0 sc1
    buffer_load_dwordx4 v[60:63], v4, s[56:59], s76 offen offset:1024 sc1
    s_waitcnt lgkmcnt(0)
    s_waitcnt vmcnt(11)
    v_mfma_f32_16x16x32_bf16 a[224:227], a[64:67], v[16:19], 0
    v_mfma_f32_16x16x32_bf16 a[228:231], a[68:71], v[16:19], 0
    v_mfma_f32_16x16x32_bf16 a[232:235], a[72:75], v[16:19], 0
    v_mfma_f32_16x16x32_bf16 a[236:239], a[76:79], v[16:19], 0
    s_waitcnt vmcnt(10)
    v_mfma_f32_16x16x32_bf16 a[224:227], a[80:83], v[20:23], a[224:227]
    v_mfma_f32_16x16x32_bf16 a[228:231], a[84:87], v[20:23], a[228:231]
    v_mfma_f32_16x16x32_bf16 a[232:235], a[88:91], v[20:23], a[232:235]
    v_mfma_f32_16x16x32_bf16 a[236:239], a[92:95], v[20:23], a[236:239]
    s_waitcnt vmcnt(9)
    v_mfma_f32_16x16x32_bf16 a[224:227], a[96:99], v[24:27], a[224:227]
    s_add_u32 s42, s3, 2
    s_and_b32 s42, s42, 3
    s_add_u32 s42, s42, s40
    s_mul_i32 s42, s42, 114688
    s_add_u32 s76, s42, s36
    buffer_load_dwordx4 v[64:67], v4, s[56:59], s76 offen offset:0 sc1
    v_mfma_f32_16x16x32_bf16 a[228:231], a[100:103], v[24:27], a[228:231]
    v_mfma_f32_16x16x32_bf16 a[232:235], a[104:107], v[24:27], a[232:235]
    v_mfma_f32_16x16x32_bf16 a[236:239], a[108:111], v[24:27], a[236:239]
    s_waitcnt vmcnt(9)
    v_mfma_f32_16x16x32_bf16 a[224:227], a[112:115], v[28:31], a[224:227]
    buffer_load_dwordx4 v[68:71], v4, s[56:59], s76 offen offset:1024 sc1
    v_mfma_f32_16x16x32_bf16 a[228:231], a[116:119], v[28:31], a[228:231]
    v_mfma_f32_16x16x32_bf16 a[232:235], a[120:123], v[28:31], a[232:235]
    v_mfma_f32_16x16x32_bf16 a[236:239], a[124:127], v[28:31], a[236:239]
    s_waitcnt vmcnt(9)
    v_mfma_f32_16x16x32_bf16 a[224:227], a[128:131], v[32:35], a[224:227]
    buffer_load_dwordx4 v[72:75], v4, s[56:59], s76 offen offset:2048 sc1
    v_mfma_f32_16x16x32_bf16 a[228:231], a[132:135], v[32:35], a[228:231]
    v_mfma_f32_16x16x32_bf16 a[232:235], a[136:139], v[32:35], a[232:235]
    v_mfma_f32_16x16x32_bf16 a[236:239], a[140:143], v[32:35], a[236:239]
    s_waitcnt vmcnt(9)
    v_mfma_f32_16x16x32_bf16 a[224:227], a[144:147], v[36:39], a[224:227]
    buffer_load_dwordx4 v[76:79], v4, s[56:59], s76 offen offset:3072 sc1
    v_mfma_f32_16x16x32_bf16 a[228:231], a[148:151], v[36:39], a[228:231]
    v_mfma_f32_16x16x32_bf16 a[232:235], a[152:155], v[36:39], a[232:235]
    v_mfma_f32_16x16x32_bf16 a[236:239], a[156:159], v[36:39], a[236:239]
    s_waitcnt vmcnt(9)
    v_mfma_f32_16x16x32_bf16 a[224:227], a[160:163], v[40:43], a[224:227]
    s_add_u32 s76, s76, 4096
    buffer_load_dwordx4 v[80:83], v4, s[56:59], s76 offen offset:0 sc1
    v_mfma_f32_16x16x32_bf16 a[228:231], a[164:167], v[40:43], a[228:231]
    v_mfma_f32_16x16x32_bf16 a[232:235], a[168:171], v[40:43], a[232:235]
    v_mfma_f32_16x16x32_bf16 a[236:239], a[172:175], v[40:43], a[236:239]
    s_waitcnt vmcnt(9)
    v_mfma_f32_16x16x32_bf16 a[224:227], a[176:179], v[44:47], a[224:227]
    buffer_load_dwordx4 v[84:87], v4, s[56:59], s76 offen offset:1024 sc1
    v_mfma_f32_16x16x32_bf16 a[228:231], a[180:183], v[44:47], a[228:231]
    v_mfma_f32_16x16x32_bf16 a[232:235], a[184:187], v[44:47], a[232:235]
    v_mfma_f32_16x16x32_bf16 a[236:239], a[188:191], v[44:47], a[236:239]
    s_waitcnt vmcnt(9)
    v_mfma_f32_16x16x32_bf16 a[224:227], a[192:195], v[48:51], a[224:227]
    s_add_u32 s76, s42, s37
    buffer_load_dwordx4 v[88:91], v4, s[56:59], s76 offen offset:0 sc1
    v_mfma_f32_16x16x32_bf16 a[228:231], a[196:199], v[48:51], a[228:231]
    v_mfma_f32_16x16x32_bf16 a[232:235], a[200:203], v[48:51], a[232:235]
    v_mfma_f32_16x16x32_bf16 a[236:239], a[204:207], v[48:51], a[236:239]
    s_waitcnt vmcnt(9)
    v_mfma_f32_16x16x32_bf16 a[224:227], a[208:211], v[52:55], a[224:227]
    buffer_load_dwordx4 v[92:95], v4, s[56:59], s76 offen offset:1024 sc1
    v_mfma_f32_16x16x32_bf16 a[228:231], a[212:215], v[52:55], a[228:231]
    v_mfma_f32_16x16x32_bf16 a[232:235], a[216:219], v[52:55], a[232:235]
    v_mfma_f32_16x16x32_bf16 a[236:239], a[220:223], v[52:55], a[236:239]
    s_waitcnt vmcnt(9)
    v_mfma_f32_16x16x32_bf16 a[224:227], a[0:3], v[56:59], a[224:227]
    buffer_load_dwordx4 v[96:99], v4, s[56:59], s76 offen offset:2048 sc1
    v_mfma_f32_16x16x32_bf16 a[228:231], a[4:7], v[56:59], a[228:231]
    v_mfma_f32_16x16x32_bf16 a[232:235], a[8:11], v[56:59], a[232:235]
    v_mfma_f32_16x16x32_bf16 a[236:239], a[12:15], v[56:59], a[236:239]
    s_waitcnt vmcnt(9)
    v_mfma_f32_16x16x32_bf16 a[224:227], a[16:19], v[60:63], a[224:227]
    buffer_load_dwordx4 v[100:103], v4, s[56:59], s76 offen offset:3072 sc1
    v_mfma_f32_16x16x32_bf16 a[228:231], a[20:23], v[60:63], a[228:231]
    v_mfma_f32_16x16x32_bf16 a[232:235], a[24:27], v[60:63], a[232:235]
    v_mfma_f32_16x16x32_bf16 a[236:239], a[28:31], v[60:63], a[236:239]
    s_waitcnt vmcnt(9)
    v_mfma_f32_16x16x32_bf16 a[240:243], a[64:67], v[64:67], 0
    s_add_u32 s76, s76, 4096
    buffer_load_dwordx4 v[104:107], v4, s[56:59], s76 offen offset:0 sc1
    v_mfma_f32_16x16x32_bf16 a[244:247], a[68:71], v[64:67], 0
    v_mfma_f32_16x16x32_bf16 a[248:251], a[72:75], v[64:67], 0
    v_mfma_f32_16x16x32_bf16 a[252:255], a[76:79], v[64:67], 0
    s_waitcnt vmcnt(9)
    v_mfma_f32_16x16x32_bf16 a[240:243], a[80:83], v[68:71], a[240:243]
    buffer_load_dwordx4 v[108:111], v4, s[56:59], s76 offen offset:1024 sc1
    v_mfma_f32_16x16x32_bf16 a[244:247], a[84:87], v[68:71], a[244:247]
    v_mfma_f32_16x16x32_bf16 a[248:251], a[88:91], v[68:71], a[248:251]
    v_mfma_f32_16x16x32_bf16 a[252:255], a[92:95], v[68:71], a[252:255]
    s_waitcnt vmcnt(9)
    v_mfma_f32_16x16x32_bf16 a[240:243], a[96:99], v[72:75], a[240:243]
    s_add_u32 s42, s3, 3
    s_and_b32 s42, s42, 3
    s_add_u32 s42, s42, s40
    s_mul_i32 s42, s42, 114688
    s_add_u32 s76, s42, s36
    buffer_load_dwordx4 v[112:115], v4, s[56:59], s76 offen offset:0 sc1
    v_mfma_f32_16x16x32_bf16 a[244:247], a[100:103], v[72:75], a[244:247]
    ds_write_b128 v232, a[224:227] offset:0

    v_mfma_f32_16x16x32_bf16 a[248:251], a[104:107], v[72:75], a[248:251]
    ds_write_b128 v232, a[228:231] offset:1024

    v_mfma_f32_16x16x32_bf16 a[252:255], a[108:111], v[72:75], a[252:255]
    ds_write_b128 v232, a[232:235] offset:2048

    s_waitcnt vmcnt(9)
    v_mfma_f32_16x16x32_bf16 a[240:243], a[112:115], v[76:79], a[240:243]
    buffer_load_dwordx4 v[116:119], v4, s[56:59], s76 offen offset:1024 sc1
    v_mfma_f32_16x16x32_bf16 a[244:247], a[116:119], v[76:79], a[244:247]
    ds_write_b128 v232, a[236:239] offset:3072

    v_mfma_f32_16x16x32_bf16 a[248:251], a[120:123], v[76:79], a[248:251]
    v_mfma_f32_16x16x32_bf16 a[252:255], a[124:127], v[76:79], a[252:255]
    s_waitcnt vmcnt(9)
    v_mfma_f32_16x16x32_bf16 a[240:243], a[128:131], v[80:83], a[240:243]
    buffer_load_dwordx4 v[120:123], v4, s[56:59], s76 offen offset:2048 sc1
    v_mfma_f32_16x16x32_bf16 a[244:247], a[132:135], v[80:83], a[244:247]
    v_mfma_f32_16x16x32_bf16 a[248:251], a[136:139], v[80:83], a[248:251]
    v_mfma_f32_16x16x32_bf16 a[252:255], a[140:143], v[80:83], a[252:255]
    s_waitcnt vmcnt(9)
    v_mfma_f32_16x16x32_bf16 a[240:243], a[144:147], v[84:87], a[240:243]
    buffer_load_dwordx4 v[124:127], v4, s[56:59], s76 offen offset:3072 sc1
    v_mfma_f32_16x16x32_bf16 a[244:247], a[148:151], v[84:87], a[244:247]
    v_mfma_f32_16x16x32_bf16 a[248:251], a[152:155], v[84:87], a[248:251]
    v_mfma_f32_16x16x32_bf16 a[252:255], a[156:159], v[84:87], a[252:255]
    s_waitcnt vmcnt(9)
    v_mfma_f32_16x16x32_bf16 a[240:243], a[160:163], v[88:91], a[240:243]
    s_add_u32 s76, s76, 4096
    buffer_load_dwordx4 v[128:131], v4, s[56:59], s76 offen offset:0 sc1
    v_mfma_f32_16x16x32_bf16 a[244:247], a[164:167], v[88:91], a[244:247]
    v_mfma_f32_16x16x32_bf16 a[248:251], a[168:171], v[88:91], a[248:251]
    v_mfma_f32_16x16x32_bf16 a[252:255], a[172:175], v[88:91], a[252:255]
    s_waitcnt vmcnt(9)
    v_mfma_f32_16x16x32_bf16 a[240:243], a[176:179], v[92:95], a[240:243]
    buffer_load_dwordx4 v[132:135], v4, s[56:59], s76 offen offset:1024 sc1
    v_mfma_f32_16x16x32_bf16 a[244:247], a[180:183], v[92:95], a[244:247]
    v_mfma_f32_16x16x32_bf16 a[248:251], a[184:187], v[92:95], a[248:251]
    v_mfma_f32_16x16x32_bf16 a[252:255], a[188:191], v[92:95], a[252:255]
    s_waitcnt vmcnt(9)
    v_mfma_f32_16x16x32_bf16 a[240:243], a[192:195], v[96:99], a[240:243]
    s_add_u32 s76, s42, s37
    buffer_load_dwordx4 v[136:139], v4, s[56:59], s76 offen offset:0 sc1
    v_mfma_f32_16x16x32_bf16 a[244:247], a[196:199], v[96:99], a[244:247]
    v_mfma_f32_16x16x32_bf16 a[248:251], a[200:203], v[96:99], a[248:251]
    v_mfma_f32_16x16x32_bf16 a[252:255], a[204:207], v[96:99], a[252:255]
    s_waitcnt vmcnt(9)
    v_mfma_f32_16x16x32_bf16 a[240:243], a[208:211], v[100:103], a[240:243]
    buffer_load_dwordx4 v[140:143], v4, s[56:59], s76 offen offset:1024 sc1
    v_mfma_f32_16x16x32_bf16 a[244:247], a[212:215], v[100:103], a[244:247]
    v_mfma_f32_16x16x32_bf16 a[248:251], a[216:219], v[100:103], a[248:251]
    v_mfma_f32_16x16x32_bf16 a[252:255], a[220:223], v[100:103], a[252:255]
    s_waitcnt vmcnt(9)
    v_mfma_f32_16x16x32_bf16 a[240:243], a[0:3], v[104:107], a[240:243]
    buffer_load_dwordx4 v[16:19], v4, s[56:59], s76 offen offset:2048 sc1
    v_mfma_f32_16x16x32_bf16 a[244:247], a[4:7], v[104:107], a[244:247]
    v_mfma_f32_16x16x32_bf16 a[248:251], a[8:11], v[104:107], a[248:251]
    v_mfma_f32_16x16x32_bf16 a[252:255], a[12:15], v[104:107], a[252:255]
    s_waitcnt vmcnt(9)
    v_mfma_f32_16x16x32_bf16 a[240:243], a[16:19], v[108:111], a[240:243]
    buffer_load_dwordx4 v[20:23], v4, s[56:59], s76 offen offset:3072 sc1
    v_mfma_f32_16x16x32_bf16 a[244:247], a[20:23], v[108:111], a[244:247]
    v_mfma_f32_16x16x32_bf16 a[248:251], a[24:27], v[108:111], a[248:251]
    v_mfma_f32_16x16x32_bf16 a[252:255], a[28:31], v[108:111], a[252:255]
    s_waitcnt vmcnt(9)
    v_mfma_f32_16x16x32_bf16 a[224:227], a[64:67], v[112:115], 0
    s_add_u32 s76, s76, 4096
    buffer_load_dwordx4 v[24:27], v4, s[56:59], s76 offen offset:0 sc1
    buffer_load_dwordx4 v[28:31], v4, s[56:59], s76 offen offset:1024 sc1
    v_mfma_f32_16x16x32_bf16 a[228:231], a[68:71], v[112:115], 0
    v_mfma_f32_16x16x32_bf16 a[232:235], a[72:75], v[112:115], 0
    v_mfma_f32_16x16x32_bf16 a[236:239], a[76:79], v[112:115], 0
    s_waitcnt vmcnt(10)
    v_mfma_f32_16x16x32_bf16 a[224:227], a[80:83], v[116:119], a[224:227]
    s_add_u32 s42, s3, 4
    s_and_b32 s42, s42, 3
    s_add_u32 s42, s42, s40
    s_mul_i32 s42, s42, 114688
    s_add_u32 s76, s42, s36
    buffer_load_dwordx4 v[32:35], v4, s[56:59], s76 offen offset:0 sc1
    buffer_load_dwordx4 v[36:39], v4, s[56:59], s76 offen offset:1024 sc1
    v_mfma_f32_16x16x32_bf16 a[228:231], a[84:87], v[116:119], a[228:231]
    v_mfma_f32_16x16x32_bf16 a[232:235], a[88:91], v[116:119], a[232:235]
    v_mfma_f32_16x16x32_bf16 a[236:239], a[92:95], v[116:119], a[236:239]
    s_waitcnt vmcnt(11)
    v_mfma_f32_16x16x32_bf16 a[224:227], a[96:99], v[120:123], a[224:227]
    buffer_load_dwordx4 v[40:43], v4, s[56:59], s76 offen offset:2048 sc1
    v_mfma_f32_16x16x32_bf16 a[228:231], a[100:103], v[120:123], a[228:231]
    ds_write_b128 v232, a[240:243] offset:4096

    v_mfma_f32_16x16x32_bf16 a[232:235], a[104:107], v[120:123], a[232:235]
    ds_write_b128 v232, a[244:247] offset:5120

    v_mfma_f32_16x16x32_bf16 a[236:239], a[108:111], v[120:123], a[236:239]
    ds_write_b128 v232, a[248:251] offset:6144

    s_waitcnt vmcnt(11)
    v_mfma_f32_16x16x32_bf16 a[224:227], a[112:115], v[124:127], a[224:227]
    buffer_load_dwordx4 v[44:47], v4, s[56:59], s76 offen offset:3072 sc1
    v_mfma_f32_16x16x32_bf16 a[228:231], a[116:119], v[124:127], a[228:231]
    ds_write_b128 v232, a[252:255] offset:7168

    v_mfma_f32_16x16x32_bf16 a[232:235], a[120:123], v[124:127], a[232:235]
    v_mfma_f32_16x16x32_bf16 a[236:239], a[124:127], v[124:127], a[236:239]
    s_waitcnt vmcnt(11)
    v_mfma_f32_16x16x32_bf16 a[224:227], a[128:131], v[128:131], a[224:227]
    s_add_u32 s76, s76, 4096
    buffer_load_dwordx4 v[48:51], v4, s[56:59], s76 offen offset:0 sc1
    v_mfma_f32_16x16x32_bf16 a[228:231], a[132:135], v[128:131], a[228:231]
    v_mfma_f32_16x16x32_bf16 a[232:235], a[136:139], v[128:131], a[232:235]
    v_mfma_f32_16x16x32_bf16 a[236:239], a[140:143], v[128:131], a[236:239]
    s_waitcnt vmcnt(11)
    v_mfma_f32_16x16x32_bf16 a[224:227], a[144:147], v[132:135], a[224:227]
    buffer_load_dwordx4 v[52:55], v4, s[56:59], s76 offen offset:1024 sc1
    v_mfma_f32_16x16x32_bf16 a[228:231], a[148:151], v[132:135], a[228:231]
    v_mfma_f32_16x16x32_bf16 a[232:235], a[152:155], v[132:135], a[232:235]
    v_mfma_f32_16x16x32_bf16 a[236:239], a[156:159], v[132:135], a[236:239]
    s_waitcnt vmcnt(11)
    v_mfma_f32_16x16x32_bf16 a[224:227], a[160:163], v[136:139], a[224:227]
    s_add_u32 s76, s42, s37
    buffer_load_dwordx4 v[56:59], v4, s[56:59], s76 offen offset:0 sc1
    v_mfma_f32_16x16x32_bf16 a[228:231], a[164:167], v[136:139], a[228:231]
    v_mfma_f32_16x16x32_bf16 a[232:235], a[168:171], v[136:139], a[232:235]
    v_mfma_f32_16x16x32_bf16 a[236:239], a[172:175], v[136:139], a[236:239]
    s_waitcnt vmcnt(11)
    v_mfma_f32_16x16x32_bf16 a[224:227], a[176:179], v[140:143], a[224:227]
    buffer_load_dwordx4 v[60:63], v4, s[56:59], s76 offen offset:1024 sc1
    v_mfma_f32_16x16x32_bf16 a[228:231], a[180:183], v[140:143], a[228:231]
    v_mfma_f32_16x16x32_bf16 a[232:235], a[184:187], v[140:143], a[232:235]
    v_mfma_f32_16x16x32_bf16 a[236:239], a[188:191], v[140:143], a[236:239]
    s_waitcnt vmcnt(11)
    v_mfma_f32_16x16x32_bf16 a[224:227], a[192:195], v[16:19], a[224:227]
    buffer_load_dwordx4 v[64:67], v4, s[56:59], s76 offen offset:2048 sc1
    v_mfma_f32_16x16x32_bf16 a[228:231], a[196:199], v[16:19], a[228:231]
    v_mfma_f32_16x16x32_bf16 a[232:235], a[200:203], v[16:19], a[232:235]
    v_mfma_f32_16x16x32_bf16 a[236:239], a[204:207], v[16:19], a[236:239]
    s_waitcnt vmcnt(11)
    v_mfma_f32_16x16x32_bf16 a[224:227], a[208:211], v[20:23], a[224:227]
    buffer_load_dwordx4 v[68:71], v4, s[56:59], s76 offen offset:3072 sc1
    v_mfma_f32_16x16x32_bf16 a[228:231], a[212:215], v[20:23], a[228:231]
    v_mfma_f32_16x16x32_bf16 a[232:235], a[216:219], v[20:23], a[232:235]
    v_mfma_f32_16x16x32_bf16 a[236:239], a[220:223], v[20:23], a[236:239]
    s_waitcnt vmcnt(11)
    v_mfma_f32_16x16x32_bf16 a[224:227], a[0:3], v[24:27], a[224:227]
    s_add_u32 s76, s76, 4096
    buffer_load_dwordx4 v[72:75], v4, s[56:59], s76 offen offset:0 sc1
    v_mfma_f32_16x16x32_bf16 a[228:231], a[4:7], v[24:27], a[228:231]
    v_mfma_f32_16x16x32_bf16 a[232:235], a[8:11], v[24:27], a[232:235]
    v_mfma_f32_16x16x32_bf16 a[236:239], a[12:15], v[24:27], a[236:239]
    s_waitcnt vmcnt(11)
    v_mfma_f32_16x16x32_bf16 a[224:227], a[16:19], v[28:31], a[224:227]
    buffer_load_dwordx4 v[76:79], v4, s[56:59], s76 offen offset:1024 sc1
    v_mfma_f32_16x16x32_bf16 a[228:231], a[20:23], v[28:31], a[228:231]
    v_mfma_f32_16x16x32_bf16 a[232:235], a[24:27], v[28:31], a[232:235]
    v_mfma_f32_16x16x32_bf16 a[236:239], a[28:31], v[28:31], a[236:239]
    s_waitcnt vmcnt(11)
    v_mfma_f32_16x16x32_bf16 v[240:243], a[64:67], v[32:35], 0
    s_add_u32 s42, s3, 1
    s_and_b32 s42, s42, 3
    s_add_u32 s42, s42, s41
    s_mul_i32 s42, s42, 114688
    s_add_u32 s76, s42, s36
    buffer_load_dwordx4 v[80:83], v4, s[56:59], s76 offen offset:0 sc1
    v_mfma_f32_16x16x32_bf16 v[244:247], a[68:71], v[32:35], 0
    v_mfma_f32_16x16x32_bf16 v[248:251], a[72:75], v[32:35], 0
    v_mfma_f32_16x16x32_bf16 v[252:255], a[76:79], v[32:35], 0
    s_waitcnt vmcnt(11)
    v_mfma_f32_16x16x32_bf16 v[240:243], a[80:83], v[36:39], v[240:243]
    buffer_load_dwordx4 v[84:87], v4, s[56:59], s76 offen offset:1024 sc1
    v_mfma_f32_16x16x32_bf16 v[244:247], a[84:87], v[36:39], v[244:247]
    v_mfma_f32_16x16x32_bf16 v[248:251], a[88:91], v[36:39], v[248:251]
    v_mfma_f32_16x16x32_bf16 v[252:255], a[92:95], v[36:39], v[252:255]
    s_waitcnt vmcnt(11)
    v_mfma_f32_16x16x32_bf16 v[240:243], a[96:99], v[40:43], v[240:243]
    buffer_load_dwordx4 v[88:91], v4, s[56:59], s76 offen offset:2048 sc1
    v_mfma_f32_16x16x32_bf16 v[244:247], a[100:103], v[40:43], v[244:247]
    ds_write_b128 v232, a[224:227] offset:8192

    v_mfma_f32_16x16x32_bf16 v[248:251], a[104:107], v[40:43], v[248:251]
    ds_write_b128 v232, a[228:231] offset:9216

    v_mfma_f32_16x16x32_bf16 v[252:255], a[108:111], v[40:43], v[252:255]
    ds_write_b128 v232, a[232:235] offset:10240

    s_waitcnt vmcnt(11)
    v_mfma_f32_16x16x32_bf16 v[240:243], a[112:115], v[44:47], v[240:243]
    buffer_load_dwordx4 v[92:95], v4, s[56:59], s76 offen offset:3072 sc1
    v_mfma_f32_16x16x32_bf16 v[244:247], a[116:119], v[44:47], v[244:247]
    ds_write_b128 v232, a[236:239] offset:11264

    v_mfma_f32_16x16x32_bf16 v[248:251], a[120:123], v[44:47], v[248:251]
    s_waitcnt lgkmcnt(0)
    s_barrier
    v_mfma_f32_16x16x32_bf16 v[252:255], a[124:127], v[44:47], v[252:255]
    ds_read_b128 v[144:147], v233 offset:0
    ds_read_b128 v[148:151], v233 offset:1024
    s_waitcnt vmcnt(11)
    v_mfma_f32_16x16x32_bf16 v[240:243], a[128:131], v[48:51], v[240:243]
    s_add_u32 s76, s76, 4096
    buffer_load_dwordx4 v[96:99], v4, s[56:59], s76 offen offset:0 sc1
    v_mfma_f32_16x16x32_bf16 v[244:247], a[132:135], v[48:51], v[244:247]
    ds_read_b128 v[152:155], v233 offset:2048
    ds_read_b128 v[156:159], v233 offset:3072
    v_mfma_f32_16x16x32_bf16 v[248:251], a[136:139], v[48:51], v[248:251]
    ds_read_b128 v[160:163], v234 offset:0
    ds_read_b128 v[164:167], v234 offset:1024
    v_mfma_f32_16x16x32_bf16 v[252:255], a[140:143], v[48:51], v[252:255]
    ds_read_b128 v[168:171], v234 offset:2048
    ds_read_b128 v[172:175], v234 offset:3072
    s_waitcnt vmcnt(11)
    v_mfma_f32_16x16x32_bf16 v[240:243], a[144:147], v[52:55], v[240:243]
    buffer_load_dwordx4 v[100:103], v4, s[56:59], s76 offen offset:1024 sc1
    v_mfma_f32_16x16x32_bf16 v[244:247], a[148:151], v[52:55], v[244:247]
    ds_read_b128 v[176:179], v235 offset:0
    ds_read_b128 v[180:183], v235 offset:1024
    v_mfma_f32_16x16x32_bf16 v[248:251], a[152:155], v[52:55], v[248:251]
    ds_read_b128 v[184:187], v235 offset:2048
    ds_read_b128 v[188:191], v235 offset:3072
    v_mfma_f32_16x16x32_bf16 v[252:255], a[156:159], v[52:55], v[252:255]
    s_waitcnt lgkmcnt(4)
    v_add_f32 v144, v144, v160
    s_waitcnt vmcnt(11)
    v_mfma_f32_16x16x32_bf16 v[240:243], a[160:163], v[56:59], v[240:243]
    s_add_u32 s76, s42, s37
    buffer_load_dwordx4 v[104:107], v4, s[56:59], s76 offen offset:0 sc1
    v_mfma_f32_16x16x32_bf16 v[244:247], a[164:167], v[56:59], v[244:247]
    v_add_f32 v145, v145, v161
    v_add_f32 v146, v146, v162
    v_mfma_f32_16x16x32_bf16 v[248:251], a[168:171], v[56:59], v[248:251]
    v_add_f32 v147, v147, v163
    v_add_f32 v148, v148, v164
    v_mfma_f32_16x16x32_bf16 v[252:255], a[172:175], v[56:59], v[252:255]
    v_add_f32 v149, v149, v165
    v_add_f32 v150, v150, v166
    s_waitcnt vmcnt(11)
    v_mfma_f32_16x16x32_bf16 v[240:243], a[176:179], v[60:63], v[240:243]
    buffer_load_dwordx4 v[108:111], v4, s[56:59], s76 offen offset:1024 sc1
    v_mfma_f32_16x16x32_bf16 v[244:247], a[180:183], v[60:63], v[244:247]
    v_add_f32 v151, v151, v167
    v_add_f32 v152, v152, v168
    v_mfma_f32_16x16x32_bf16 v[248:251], a[184:187], v[60:63], v[248:251]
    v_add_f32 v153, v153, v169
    v_add_f32 v154, v154, v170
    v_mfma_f32_16x16x32_bf16 v[252:255], a[188:191], v[60:63], v[252:255]
    v_add_f32 v155, v155, v171
    v_add_f32 v156, v156, v172
    s_waitcnt vmcnt(11)
    v_mfma_f32_16x16x32_bf16 v[240:243], a[192:195], v[64:67], v[240:243]
    buffer_load_dwordx4 v[112:115], v4, s[56:59], s76 offen offset:2048 sc1
    v_mfma_f32_16x16x32_bf16 v[244:247], a[196:199], v[64:67], v[244:247]
    v_add_f32 v157, v157, v173
    v_add_f32 v158, v158, v174
    v_mfma_f32_16x16x32_bf16 v[248:251], a[200:203], v[64:67], v[248:251]
    v_add_f32 v159, v159, v175
    s_waitcnt lgkmcnt(0)
    v_mfma_f32_16x16x32_bf16 v[252:255], a[204:207], v[64:67], v[252:255]
    v_add_f32 v144, v144, v176
    v_add_f32 v145, v145, v177
    s_waitcnt vmcnt(11)
    v_mfma_f32_16x16x32_bf16 v[240:243], a[208:211], v[68:71], v[240:243]
    buffer_load_dwordx4 v[116:119], v4, s[56:59], s76 offen offset:3072 sc1
    v_mfma_f32_16x16x32_bf16 v[244:247], a[212:215], v[68:71], v[244:247]
    v_add_f32 v146, v146, v178
    v_add_f32 v147, v147, v179
    v_mfma_f32_16x16x32_bf16 v[248:251], a[216:219], v[68:71], v[248:251]
    v_add_f32 v148, v148, v180
    v_add_f32 v149, v149, v181
    v_mfma_f32_16x16x32_bf16 v[252:255], a[220:223], v[68:71], v[252:255]
    v_add_f32 v150, v150, v182
    v_add_f32 v151, v151, v183
    s_waitcnt vmcnt(11)
    v_mfma_f32_16x16x32_bf16 v[240:243], a[0:3], v[72:75], v[240:243]
    s_add_u32 s76, s76, 4096
    buffer_load_dwordx4 v[120:123], v4, s[56:59], s76 offen offset:0 sc1
    v_mfma_f32_16x16x32_bf16 v[244:247], a[4:7], v[72:75], v[244:247]
    v_add_f32 v152, v152, v184
    v_add_f32 v153, v153, v185
    v_mfma_f32_16x16x32_bf16 v[248:251], a[8:11], v[72:75], v[248:251]
    v_add_f32 v154, v154, v186
    v_add_f32 v155, v155, v187
    v_mfma_f32_16x16x32_bf16 v[252:255], a[12:15], v[72:75], v[252:255]
    v_add_f32 v156, v156, v188
    v_add_f32 v157, v157, v189
    s_waitcnt vmcnt(11)
    v_mfma_f32_16x16x32_bf16 v[240:243], a[16:19], v[76:79], v[240:243]
    buffer_load_dwordx4 v[124:127], v4, s[56:59], s76 offen offset:1024 sc1
    v_mfma_f32_16x16x32_bf16 v[244:247], a[20:23], v[76:79], v[244:247]
    v_add_f32 v158, v158, v190
    v_add_f32 v159, v159, v191
    v_mfma_f32_16x16x32_bf16 v[248:251], a[24:27], v[76:79], v[248:251]
    v_mfma_f32_16x16x32_bf16 v[252:255], a[28:31], v[76:79], v[252:255]
    s_waitcnt vmcnt(11)
    v_mfma_f32_16x16x32_bf16 a[224:227], a[64:67], v[80:83], 0
    s_add_u32 s42, s3, 2
    s_and_b32 s42, s42, 3
    s_add_u32 s42, s42, s41
    s_mul_i32 s42, s42, 114688
    s_add_u32 s76, s42, s36
    buffer_load_dwordx4 v[128:131], v4, s[56:59], s76 offen offset:0 sc1
    v_mfma_f32_16x16x32_bf16 a[228:231], a[68:71], v[80:83], 0
    v_mfma_f32_16x16x32_bf16 a[232:235], a[72:75], v[80:83], 0
    v_mfma_f32_16x16x32_bf16 a[236:239], a[76:79], v[80:83], 0
    s_waitcnt vmcnt(11)
    v_mfma_f32_16x16x32_bf16 a[224:227], a[80:83], v[84:87], a[224:227]
    buffer_load_dwordx4 v[132:135], v4, s[56:59], s76 offen offset:1024 sc1
    v_mfma_f32_16x16x32_bf16 a[228:231], a[84:87], v[84:87], a[228:231]
    v_mfma_f32_16x16x32_bf16 a[232:235], a[88:91], v[84:87], a[232:235]
    v_mfma_f32_16x16x32_bf16 a[236:239], a[92:95], v[84:87], a[236:239]
    s_waitcnt vmcnt(11)
    v_mfma_f32_16x16x32_bf16 a[224:227], a[96:99], v[88:91], a[224:227]
    buffer_load_dwordx4 v[136:139], v4, s[56:59], s76 offen offset:2048 sc1
    v_mfma_f32_16x16x32_bf16 a[228:231], a[100:103], v[88:91], a[228:231]
    v_add_f32 v144, v144, v240
    v_add_f32 v145, v145, v241
    v_mfma_f32_16x16x32_bf16 a[232:235], a[104:107], v[88:91], a[232:235]
    v_add_f32 v146, v146, v242
    v_add_f32 v147, v147, v243
    v_mfma_f32_16x16x32_bf16 a[236:239], a[108:111], v[88:91], a[236:239]
    v_add_f32 v148, v148, v244
    v_add_f32 v149, v149, v245
    s_waitcnt vmcnt(11)
    v_mfma_f32_16x16x32_bf16 a[224:227], a[112:115], v[92:95], a[224:227]
    buffer_load_dwordx4 v[140:143], v4, s[56:59], s76 offen offset:3072 sc1
    v_mfma_f32_16x16x32_bf16 a[228:231], a[116:119], v[92:95], a[228:231]
    v_add_f32 v150, v150, v246
    v_add_f32 v151, v151, v247
    v_mfma_f32_16x16x32_bf16 a[232:235], a[120:123], v[92:95], a[232:235]
    v_add_f32 v152, v152, v248
    v_add_f32 v153, v153, v249
    v_mfma_f32_16x16x32_bf16 a[236:239], a[124:127], v[92:95], a[236:239]
    v_add_f32 v154, v154, v250
    v_add_f32 v155, v155, v251
    s_waitcnt vmcnt(11)
    v_mfma_f32_16x16x32_bf16 a[224:227], a[128:131], v[96:99], a[224:227]
    s_add_u32 s76, s76, 4096
    buffer_load_dwordx4 v[16:19], v4, s[56:59], s76 offen offset:0 sc1
    v_mfma_f32_16x16x32_bf16 a[228:231], a[132:135], v[96:99], a[228:231]
    v_add_f32 v156, v156, v252
    v_add_f32 v157, v157, v253
    v_mfma_f32_16x16x32_bf16 a[232:235], a[136:139], v[96:99], a[232:235]
    v_add_f32 v158, v158, v254
    v_add_f32 v159, v159, v255
    v_mfma_f32_16x16x32_bf16 a[236:239], a[140:143], v[96:99], a[236:239]
    v_bfi_b32 v144, v228, v224, v144
    v_bfi_b32 v145, v228, v225, v145
    s_waitcnt vmcnt(11)
    v_mfma_f32_16x16x32_bf16 a[224:227], a[144:147], v[100:103], a[224:227]
    buffer_load_dwordx4 v[20:23], v4, s[56:59], s76 offen offset:1024 sc1
    v_mfma_f32_16x16x32_bf16 a[228:231], a[148:151], v[100:103], a[228:231]
    v_bfi_b32 v146, v228, v226, v146
    v_bfi_b32 v147, v228, v227, v147
    v_mfma_f32_16x16x32_bf16 a[232:235], a[152:155], v[100:103], a[232:235]
    v_bfi_b32 v148, v228, v224, v148
    v_bfi_b32 v149, v228, v225, v149
    v_mfma_f32_16x16x32_bf16 a[236:239], a[156:159], v[100:103], a[236:239]
    v_bfi_b32 v150, v228, v226, v150
    v_bfi_b32 v151, v228, v227, v151
    s_waitcnt vmcnt(11)
    v_mfma_f32_16x16x32_bf16 a[224:227], a[160:163], v[104:107], a[224:227]
    s_add_u32 s76, s42, s37
    buffer_load_dwordx4 v[24:27], v4, s[56:59], s76 offen offset:0 sc1
    v_mfma_f32_16x16x32_bf16 a[228:231], a[164:167], v[104:107], a[228:231]
    v_bfi_b32 v152, v228, v224, v152
    v_bfi_b32 v153, v228, v225, v153
    v_mfma_f32_16x16x32_bf16 a[232:235], a[168:171], v[104:107], a[232:235]
    v_bfi_b32 v154, v228, v226, v154
    v_bfi_b32 v155, v228, v227, v155
    v_mfma_f32_16x16x32_bf16 a[236:239], a[172:175], v[104:107], a[236:239]
    v_bfi_b32 v156, v228, v224, v156
    v_bfi_b32 v157, v228, v225, v157
    s_waitcnt vmcnt(11)
    v_mfma_f32_16x16x32_bf16 a[224:227], a[176:179], v[108:111], a[224:227]
    buffer_load_dwordx4 v[28:31], v4, s[56:59], s76 offen offset:1024 sc1
    v_mfma_f32_16x16x32_bf16 a[228:231], a[180:183], v[108:111], a[228:231]
    v_bfi_b32 v158, v228, v226, v158
    v_bfi_b32 v159, v228, v227, v159
    v_mfma_f32_16x16x32_bf16 a[232:235], a[184:187], v[108:111], a[232:235]
    v_mfma_f32_16x16x32_bf16 a[236:239], a[188:191], v[108:111], a[236:239]
    buffer_store_dwordx4 v[144:147], v4, s[56:59], s94 offen offset:0 sc1
    buffer_store_dwordx4 v[148:151], v4, s[56:59], s94 offen offset:1024 sc1
    buffer_store_dwordx4 v[152:155], v4, s[56:59], s94 offen offset:2048 sc1
    buffer_store_dwordx4 v[156:159], v4, s[56:59], s94 offen offset:3072 sc1
    s_waitcnt vmcnt(15)
    v_mfma_f32_16x16x32_bf16 a[224:227], a[192:195], v[112:115], a[224:227]
    buffer_load_dwordx4 v[32:35], v4, s[56:59], s76 offen offset:2048 sc1
    v_mfma_f32_16x16x32_bf16 a[228:231], a[196:199], v[112:115], a[228:231]
    v_mfma_f32_16x16x32_bf16 a[232:235], a[200:203], v[112:115], a[232:235]
    v_mfma_f32_16x16x32_bf16 a[236:239], a[204:207], v[112:115], a[236:239]
    s_waitcnt vmcnt(15)
    v_mfma_f32_16x16x32_bf16 a[224:227], a[208:211], v[116:119], a[224:227]
    buffer_load_dwordx4 v[36:39], v4, s[56:59], s76 offen offset:3072 sc1
    v_mfma_f32_16x16x32_bf16 a[228:231], a[212:215], v[116:119], a[228:231]
    v_mfma_f32_16x16x32_bf16 a[232:235], a[216:219], v[116:119], a[232:235]
    v_mfma_f32_16x16x32_bf16 a[236:239], a[220:223], v[116:119], a[236:239]
    s_waitcnt vmcnt(15)
    v_mfma_f32_16x16x32_bf16 a[224:227], a[0:3], v[120:123], a[224:227]
    s_add_u32 s76, s76, 4096
    buffer_load_dwordx4 v[40:43], v4, s[56:59], s76 offen offset:0 sc1
    v_mfma_f32_16x16x32_bf16 a[228:231], a[4:7], v[120:123], a[228:231]
    v_mfma_f32_16x16x32_bf16 a[232:235], a[8:11], v[120:123], a[232:235]
    v_mfma_f32_16x16x32_bf16 a[236:239], a[12:15], v[120:123], a[236:239]
    s_waitcnt vmcnt(15)
    v_mfma_f32_16x16x32_bf16 a[224:227], a[16:19], v[124:127], a[224:227]
    buffer_load_dwordx4 v[44:47], v4, s[56:59], s76 offen offset:1024 sc1
    v_mfma_f32_16x16x32_bf16 a[228:231], a[20:23], v[124:127], a[228:231]
    v_mfma_f32_16x16x32_bf16 a[232:235], a[24:27], v[124:127], a[232:235]
    v_mfma_f32_16x16x32_bf16 a[236:239], a[28:31], v[124:127], a[236:239]
    s_waitcnt vmcnt(15)
    v_mfma_f32_16x16x32_bf16 a[240:243], a[64:67], v[128:131], 0
    s_add_u32 s42, s3, 3
    s_and_b32 s42, s42, 3
    s_add_u32 s42, s42, s41
    s_mul_i32 s42, s42, 114688
    s_add_u32 s76, s42, s36
    buffer_load_dwordx4 v[48:51], v4, s[56:59], s76 offen offset:0 sc1
    v_mfma_f32_16x16x32_bf16 a[244:247], a[68:71], v[128:131], 0
    v_mfma_f32_16x16x32_bf16 a[248:251], a[72:75], v[128:131], 0
    v_mfma_f32_16x16x32_bf16 a[252:255], a[76:79], v[128:131], 0
    s_waitcnt vmcnt(15)
    v_mfma_f32_16x16x32_bf16 a[240:243], a[80:83], v[132:135], a[240:243]
    buffer_load_dwordx4 v[52:55], v4, s[56:59], s76 offen offset:1024 sc1
    v_mfma_f32_16x16x32_bf16 a[244:247], a[84:87], v[132:135], a[244:247]
    v_mfma_f32_16x16x32_bf16 a[248:251], a[88:91], v[132:135], a[248:251]
    v_mfma_f32_16x16x32_bf16 a[252:255], a[92:95], v[132:135], a[252:255]
    s_waitcnt vmcnt(15)
    v_mfma_f32_16x16x32_bf16 a[240:243], a[96:99], v[136:139], a[240:243]
    buffer_load_dwordx4 v[56:59], v4, s[56:59], s76 offen offset:2048 sc1
    v_mfma_f32_16x16x32_bf16 a[244:247], a[100:103], v[136:139], a[244:247]
    ds_write_b128 v232, a[224:227] offset:20480

    v_mfma_f32_16x16x32_bf16 a[248:251], a[104:107], v[136:139], a[248:251]
    ds_write_b128 v232, a[228:231] offset:21504

    v_mfma_f32_16x16x32_bf16 a[252:255], a[108:111], v[136:139], a[252:255]
    ds_write_b128 v232, a[232:235] offset:22528

    s_waitcnt vmcnt(15)
    v_mfma_f32_16x16x32_bf16 a[240:243], a[112:115], v[140:143], a[240:243]
    buffer_load_dwordx4 v[60:63], v4, s[56:59], s76 offen offset:3072 sc1
    v_mfma_f32_16x16x32_bf16 a[244:247], a[116:119], v[140:143], a[244:247]
    ds_write_b128 v232, a[236:239] offset:23552

    v_mfma_f32_16x16x32_bf16 a[248:251], a[120:123], v[140:143], a[248:251]
    v_mfma_f32_16x16x32_bf16 a[252:255], a[124:127], v[140:143], a[252:255]
    s_waitcnt vmcnt(15)
    v_mfma_f32_16x16x32_bf16 a[240:243], a[128:131], v[16:19], a[240:243]
    s_add_u32 s76, s76, 4096
    buffer_load_dwordx4 v[64:67], v4, s[56:59], s76 offen offset:0 sc1
    v_mfma_f32_16x16x32_bf16 a[244:247], a[132:135], v[16:19], a[244:247]
    v_mfma_f32_16x16x32_bf16 a[248:251], a[136:139], v[16:19], a[248:251]
    v_mfma_f32_16x16x32_bf16 a[252:255], a[140:143], v[16:19], a[252:255]
    s_waitcnt vmcnt(15)
    v_mfma_f32_16x16x32_bf16 a[240:243], a[144:147], v[20:23], a[240:243]
    buffer_load_dwordx4 v[68:71], v4, s[56:59], s76 offen offset:1024 sc1
    v_mfma_f32_16x16x32_bf16 a[244:247], a[148:151], v[20:23], a[244:247]
    v_mfma_f32_16x16x32_bf16 a[248:251], a[152:155], v[20:23], a[248:251]
    v_mfma_f32_16x16x32_bf16 a[252:255], a[156:159], v[20:23], a[252:255]
    s_waitcnt vmcnt(15)
    v_mfma_f32_16x16x32_bf16 a[240:243], a[160:163], v[24:27], a[240:243]
    s_add_u32 s76, s42, s37
    buffer_load_dwordx4 v[72:75], v4, s[56:59], s76 offen offset:0 sc1
    v_mfma_f32_16x16x32_bf16 a[244:247], a[164:167], v[24:27], a[244:247]
    v_mfma_f32_16x16x32_bf16 a[248:251], a[168:171], v[24:27], a[248:251]
    v_mfma_f32_16x16x32_bf16 a[252:255], a[172:175], v[24:27], a[252:255]
    s_waitcnt vmcnt(15)
    v_mfma_f32_16x16x32_bf16 a[240:243], a[176:179], v[28:31], a[240:243]
    buffer_load_dwordx4 v[76:79], v4, s[56:59], s76 offen offset:1024 sc1
    v_mfma_f32_16x16x32_bf16 a[244:247], a[180:183], v[28:31], a[244:247]
    v_mfma_f32_16x16x32_bf16 a[248:251], a[184:187], v[28:31], a[248:251]
    v_mfma_f32_16x16x32_bf16 a[252:255], a[188:191], v[28:31], a[252:255]
    s_waitcnt vmcnt(11)
    v_mfma_f32_16x16x32_bf16 a[240:243], a[192:195], v[32:35], a[240:243]
    buffer_load_dwordx4 v[80:83], v4, s[56:59], s76 offen offset:2048 sc1
    buffer_load_dwordx4 v[84:87], v4, s[56:59], s76 offen offset:3072 sc1
    v_mfma_f32_16x16x32_bf16 a[244:247], a[196:199], v[32:35], a[244:247]
    v_mfma_f32_16x16x32_bf16 a[248:251], a[200:203], v[32:35], a[248:251]
    v_mfma_f32_16x16x32_bf16 a[252:255], a[204:207], v[32:35], a[252:255]
    s_waitcnt vmcnt(12)
    v_mfma_f32_16x16x32_bf16 a[240:243], a[208:211], v[36:39], a[240:243]
    v_mfma_f32_16x16x32_bf16 a[244:247], a[212:215], v[36:39], a[244:247]
    v_mfma_f32_16x16x32_bf16 a[248:251], a[216:219], v[36:39], a[248:251]
    v_mfma_f32_16x16x32_bf16 a[252:255], a[220:223], v[36:39], a[252:255]
    s_waitcnt vmcnt(11)
    v_mfma_f32_16x16x32_bf16 a[240:243], a[0:3], v[40:43], a[240:243]
    v_mfma_f32_16x16x32_bf16 a[244:247], a[4:7], v[40:43], a[244:247]
    v_mfma_f32_16x16x32_bf16 a[248:251], a[8:11], v[40:43], a[248:251]
    v_mfma_f32_16x16x32_bf16 a[252:255], a[12:15], v[40:43], a[252:255]
    s_waitcnt vmcnt(10)
    v_mfma_f32_16x16x32_bf16 a[240:243], a[16:19], v[44:47], a[240:243]
    v_mfma_f32_16x16x32_bf16 a[244:247], a[20:23], v[44:47], a[244:247]
    v_mfma_f32_16x16x32_bf16 a[248:251], a[24:27], v[44:47], a[248:251]
    v_mfma_f32_16x16x32_bf16 a[252:255], a[28:31], v[44:47], a[252:255]
    s_waitcnt vmcnt(9)
    v_mfma_f32_16x16x32_bf16 a[224:227], a[64:67], v[48:51], 0
    s_add_u32 s76, s76, 4096
    buffer_load_dwordx4 v[88:91], v4, s[56:59], s76 offen offset:0 sc1
    v_mfma_f32_16x16x32_bf16 a[228:231], a[68:71], v[48:51], 0
    v_mfma_f32_16x16x32_bf16 a[232:235], a[72:75], v[48:51], 0
    v_mfma_f32_16x16x32_bf16 a[236:239], a[76:79], v[48:51], 0
    s_waitcnt vmcnt(9)
    v_mfma_f32_16x16x32_bf16 a[224:227], a[80:83], v[52:55], a[224:227]
    buffer_load_dwordx4 v[92:95], v4, s[56:59], s76 offen offset:1024 sc1
    v_mfma_f32_16x16x32_bf16 a[228:231], a[84:87], v[52:55], a[228:231]
    v_mfma_f32_16x16x32_bf16 a[232:235], a[88:91], v[52:55], a[232:235]
    v_mfma_f32_16x16x32_bf16 a[236:239], a[92:95], v[52:55], a[236:239]
    s_waitcnt vmcnt(9)
    v_mfma_f32_16x16x32_bf16 a[224:227], a[96:99], v[56:59], a[224:227]
    s_add_u32 s42, s3, 4
    s_and_b32 s42, s42, 3
    s_add_u32 s42, s42, s41
    s_mul_i32 s42, s42, 114688
    s_add_u32 s76, s42, s36
    buffer_load_dwordx4 v[96:99], v4, s[56:59], s76 offen offset:0 sc1
    v_mfma_f32_16x16x32_bf16 a[228:231], a[100:103], v[56:59], a[228:231]
    ds_write_b128 v232, a[240:243] offset:24576

    v_mfma_f32_16x16x32_bf16 a[232:235], a[104:107], v[56:59], a[232:235]
    ds_write_b128 v232, a[244:247] offset:25600

    v_mfma_f32_16x16x32_bf16 a[236:239], a[108:111], v[56:59], a[236:239]
    ds_write_b128 v232, a[248:251] offset:26624

    s_waitcnt vmcnt(9)
    v_mfma_f32_16x16x32_bf16 a[224:227], a[112:115], v[60:63], a[224:227]
    buffer_load_dwordx4 v[100:103], v4, s[56:59], s76 offen offset:1024 sc1
    v_mfma_f32_16x16x32_bf16 a[228:231], a[116:119], v[60:63], a[228:231]
    ds_write_b128 v232, a[252:255] offset:27648

    v_mfma_f32_16x16x32_bf16 a[232:235], a[120:123], v[60:63], a[232:235]
    v_mfma_f32_16x16x32_bf16 a[236:239], a[124:127], v[60:63], a[236:239]
    s_waitcnt vmcnt(9)
    v_mfma_f32_16x16x32_bf16 a[224:227], a[128:131], v[64:67], a[224:227]
    buffer_load_dwordx4 v[104:107], v4, s[56:59], s76 offen offset:2048 sc1
    v_mfma_f32_16x16x32_bf16 a[228:231], a[132:135], v[64:67], a[228:231]
    v_mfma_f32_16x16x32_bf16 a[232:235], a[136:139], v[64:67], a[232:235]
    v_mfma_f32_16x16x32_bf16 a[236:239], a[140:143], v[64:67], a[236:239]
    s_waitcnt vmcnt(9)
    v_mfma_f32_16x16x32_bf16 a[224:227], a[144:147], v[68:71], a[224:227]
    buffer_load_dwordx4 v[108:111], v4, s[56:59], s76 offen offset:3072 sc1
    v_mfma_f32_16x16x32_bf16 a[228:231], a[148:151], v[68:71], a[228:231]
    v_mfma_f32_16x16x32_bf16 a[232:235], a[152:155], v[68:71], a[232:235]
    v_mfma_f32_16x16x32_bf16 a[236:239], a[156:159], v[68:71], a[236:239]
    s_waitcnt vmcnt(9)
    v_mfma_f32_16x16x32_bf16 a[224:227], a[160:163], v[72:75], a[224:227]
    s_add_u32 s76, s76, 4096
    buffer_load_dwordx4 v[112:115], v4, s[56:59], s76 offen offset:0 sc1
    v_mfma_f32_16x16x32_bf16 a[228:231], a[164:167], v[72:75], a[228:231]
    v_mfma_f32_16x16x32_bf16 a[232:235], a[168:171], v[72:75], a[232:235]
    v_mfma_f32_16x16x32_bf16 a[236:239], a[172:175], v[72:75], a[236:239]
    s_waitcnt vmcnt(9)
    v_mfma_f32_16x16x32_bf16 a[224:227], a[176:179], v[76:79], a[224:227]
    buffer_load_dwordx4 v[116:119], v4, s[56:59], s76 offen offset:1024 sc1
    v_mfma_f32_16x16x32_bf16 a[228:231], a[180:183], v[76:79], a[228:231]
    v_mfma_f32_16x16x32_bf16 a[232:235], a[184:187], v[76:79], a[232:235]
    v_mfma_f32_16x16x32_bf16 a[236:239], a[188:191], v[76:79], a[236:239]
    s_waitcnt vmcnt(9)
    v_mfma_f32_16x16x32_bf16 a[224:227], a[192:195], v[80:83], a[224:227]
    buffer_load_dwordx4 v[208:211], v4, s[56:59], s95 offen offset:0 sc1
    v_mfma_f32_16x16x32_bf16 a[228:231], a[196:199], v[80:83], a[228:231]
    v_mfma_f32_16x16x32_bf16 a[232:235], a[200:203], v[80:83], a[232:235]
    v_mfma_f32_16x16x32_bf16 a[236:239], a[204:207], v[80:83], a[236:239]
    s_waitcnt vmcnt(9)
    v_mfma_f32_16x16x32_bf16 a[224:227], a[208:211], v[84:87], a[224:227]
    buffer_load_dwordx4 v[212:215], v4, s[56:59], s95 offen offset:1024 sc1
    v_mfma_f32_16x16x32_bf16 a[228:231], a[212:215], v[84:87], a[228:231]
    v_mfma_f32_16x16x32_bf16 a[232:235], a[216:219], v[84:87], a[232:235]
    v_mfma_f32_16x16x32_bf16 a[236:239], a[220:223], v[84:87], a[236:239]
    s_waitcnt vmcnt(9)
    v_mfma_f32_16x16x32_bf16 a[224:227], a[0:3], v[88:91], a[224:227]
    buffer_load_dwordx4 v[216:219], v4, s[56:59], s95 offen offset:2048 sc1
    v_mfma_f32_16x16x32_bf16 a[228:231], a[4:7], v[88:91], a[228:231]
    v_mfma_f32_16x16x32_bf16 a[232:235], a[8:11], v[88:91], a[232:235]
    v_mfma_f32_16x16x32_bf16 a[236:239], a[12:15], v[88:91], a[236:239]
    s_waitcnt vmcnt(9)
    v_mfma_f32_16x16x32_bf16 a[224:227], a[16:19], v[92:95], a[224:227]
    buffer_load_dwordx4 v[220:223], v4, s[56:59], s95 offen offset:3072 sc1
    v_mfma_f32_16x16x32_bf16 a[228:231], a[20:23], v[92:95], a[228:231]
    v_mfma_f32_16x16x32_bf16 a[232:235], a[24:27], v[92:95], a[232:235]
    v_mfma_f32_16x16x32_bf16 a[236:239], a[28:31], v[92:95], a[236:239]
    s_waitcnt vmcnt(9)
    v_mfma_f32_16x16x32_bf16 v[240:243], a[64:67], v[96:99], 0
    s_add_u32 s76, s42, s37
    buffer_load_dwordx4 v[120:123], v4, s[56:59], s76 offen offset:0 sc1
    v_mfma_f32_16x16x32_bf16 v[244:247], a[68:71], v[96:99], 0
    v_mfma_f32_16x16x32_bf16 v[248:251], a[72:75], v[96:99], 0
    v_mfma_f32_16x16x32_bf16 v[252:255], a[76:79], v[96:99], 0
    s_waitcnt vmcnt(9)
    v_mfma_f32_16x16x32_bf16 v[240:243], a[80:83], v[100:103], v[240:243]
    buffer_load_dwordx4 v[124:127], v4, s[56:59], s76 offen offset:1024 sc1
    v_mfma_f32_16x16x32_bf16 v[244:247], a[84:87], v[100:103], v[244:247]
    v_mfma_f32_16x16x32_bf16 v[248:251], a[88:91], v[100:103], v[248:251]
    v_mfma_f32_16x16x32_bf16 v[252:255], a[92:95], v[100:103], v[252:255]
    s_waitcnt vmcnt(9)
    v_mfma_f32_16x16x32_bf16 v[240:243], a[96:99], v[104:107], v[240:243]
    buffer_load_dwordx4 v[128:131], v4, s[56:59], s76 offen offset:2048 sc1
    v_mfma_f32_16x16x32_bf16 v[244:247], a[100:103], v[104:107], v[244:247]
    ds_write_b128 v232, a[224:227] offset:28672

    v_mfma_f32_16x16x32_bf16 v[248:251], a[104:107], v[104:107], v[248:251]
    ds_write_b128 v232, a[228:231] offset:29696

    v_mfma_f32_16x16x32_bf16 v[252:255], a[108:111], v[104:107], v[252:255]
    ds_write_b128 v232, a[232:235] offset:30720

    s_waitcnt vmcnt(9)
    v_mfma_f32_16x16x32_bf16 v[240:243], a[112:115], v[108:111], v[240:243]
    buffer_load_dwordx4 v[132:135], v4, s[56:59], s76 offen offset:3072 sc1
    v_mfma_f32_16x16x32_bf16 v[244:247], a[116:119], v[108:111], v[244:247]
    ds_write_b128 v232, a[236:239] offset:31744

    v_mfma_f32_16x16x32_bf16 v[248:251], a[120:123], v[108:111], v[248:251]
    s_waitcnt lgkmcnt(0)
    s_barrier
    v_mfma_f32_16x16x32_bf16 v[252:255], a[124:127], v[108:111], v[252:255]
    ds_read_b128 v[144:147], v233 offset:20480
    ds_read_b128 v[148:151], v233 offset:21504
    s_waitcnt vmcnt(9)
    v_mfma_f32_16x16x32_bf16 v[240:243], a[128:131], v[112:115], v[240:243]
    s_add_u32 s76, s76, 4096
    buffer_load_dwordx4 v[136:139], v4, s[56:59], s76 offen offset:0 sc1
    v_mfma_f32_16x16x32_bf16 v[244:247], a[132:135], v[112:115], v[244:247]
    ds_read_b128 v[152:155], v233 offset:22528
    ds_read_b128 v[156:159], v233 offset:23552
    v_mfma_f32_16x16x32_bf16 v[248:251], a[136:139], v[112:115], v[248:251]
    ds_read_b128 v[160:163], v234 offset:20480
    ds_read_b128 v[164:167], v234 offset:21504
    v_mfma_f32_16x16x32_bf16 v[252:255], a[140:143], v[112:115], v[252:255]
    ds_read_b128 v[168:171], v234 offset:22528
    ds_read_b128 v[172:175], v234 offset:23552
    s_waitcnt vmcnt(9)
    v_mfma_f32_16x16x32_bf16 v[240:243], a[144:147], v[116:119], v[240:243]
    buffer_load_dwordx4 v[140:143], v4, s[56:59], s76 offen offset:1024 sc1
    v_mfma_f32_16x16x32_bf16 v[244:247], a[148:151], v[116:119], v[244:247]
    ds_read_b128 v[176:179], v235 offset:20480
    ds_read_b128 v[180:183], v235 offset:21504
    v_mfma_f32_16x16x32_bf16 v[248:251], a[152:155], v[116:119], v[248:251]
    ds_read_b128 v[184:187], v235 offset:22528
    ds_read_b128 v[188:191], v235 offset:23552
    v_mfma_f32_16x16x32_bf16 v[252:255], a[156:159], v[116:119], v[252:255]
    s_waitcnt lgkmcnt(4)
    v_add_f32 v144, v144, v160
    s_waitcnt vmcnt(5)
    v_mfma_f32_16x16x32_bf16 v[240:243], a[160:163], v[120:123], v[240:243]
    v_mfma_f32_16x16x32_bf16 v[244:247], a[164:167], v[120:123], v[244:247]
    v_add_f32 v145, v145, v161
    v_add_f32 v146, v146, v162
    v_mfma_f32_16x16x32_bf16 v[248:251], a[168:171], v[120:123], v[248:251]
    v_add_f32 v147, v147, v163
    v_add_f32 v148, v148, v164
    v_mfma_f32_16x16x32_bf16 v[252:255], a[172:175], v[120:123], v[252:255]
    v_add_f32 v149, v149, v165
    v_add_f32 v150, v150, v166
    s_waitcnt vmcnt(4)
    v_mfma_f32_16x16x32_bf16 v[240:243], a[176:179], v[124:127], v[240:243]
    v_mfma_f32_16x16x32_bf16 v[244:247], a[180:183], v[124:127], v[244:247]
    v_add_f32 v151, v151, v167
    v_add_f32 v152, v152, v168
    v_mfma_f32_16x16x32_bf16 v[248:251], a[184:187], v[124:127], v[248:251]
    v_add_f32 v153, v153, v169
    v_add_f32 v154, v154, v170
    v_mfma_f32_16x16x32_bf16 v[252:255], a[188:191], v[124:127], v[252:255]
    v_add_f32 v155, v155, v171
    v_add_f32 v156, v156, v172
    s_waitcnt vmcnt(3)
    v_mfma_f32_16x16x32_bf16 v[240:243], a[192:195], v[128:131], v[240:243]
    v_mfma_f32_16x16x32_bf16 v[244:247], a[196:199], v[128:131], v[244:247]
    v_add_f32 v157, v157, v173
    v_add_f32 v158, v158, v174
    v_mfma_f32_16x16x32_bf16 v[248:251], a[200:203], v[128:131], v[248:251]
    v_add_f32 v159, v159, v175
    s_waitcnt lgkmcnt(0)
    v_mfma_f32_16x16x32_bf16 v[252:255], a[204:207], v[128:131], v[252:255]
    v_add_f32 v144, v144, v176
    v_add_f32 v145, v145, v177
    s_waitcnt vmcnt(2)
    v_mfma_f32_16x16x32_bf16 v[240:243], a[208:211], v[132:135], v[240:243]
    v_mfma_f32_16x16x32_bf16 v[244:247], a[212:215], v[132:135], v[244:247]
    v_add_f32 v146, v146, v178
    v_add_f32 v147, v147, v179
    v_mfma_f32_16x16x32_bf16 v[248:251], a[216:219], v[132:135], v[248:251]
    v_add_f32 v148, v148, v180
    v_add_f32 v149, v149, v181
    v_mfma_f32_16x16x32_bf16 v[252:255], a[220:223], v[132:135], v[252:255]
    v_add_f32 v150, v150, v182
    v_add_f32 v151, v151, v183
    s_waitcnt vmcnt(1)
    v_mfma_f32_16x16x32_bf16 v[240:243], a[0:3], v[136:139], v[240:243]
    v_mfma_f32_16x16x32_bf16 v[244:247], a[4:7], v[136:139], v[244:247]
    v_add_f32 v152, v152, v184
    v_add_f32 v153, v153, v185
    v_mfma_f32_16x16x32_bf16 v[248:251], a[8:11], v[136:139], v[248:251]
    v_add_f32 v154, v154, v186
    v_add_f32 v155, v155, v187
    v_mfma_f32_16x16x32_bf16 v[252:255], a[12:15], v[136:139], v[252:255]
    v_add_f32 v156, v156, v188
    v_add_f32 v157, v157, v189
    s_waitcnt vmcnt(0)
    v_mfma_f32_16x16x32_bf16 v[240:243], a[16:19], v[140:143], v[240:243]
    v_mfma_f32_16x16x32_bf16 v[244:247], a[20:23], v[140:143], v[244:247]
    v_add_f32 v158, v158, v190
    v_add_f32 v159, v159, v191
    v_mfma_f32_16x16x32_bf16 v[248:251], a[24:27], v[140:143], v[248:251]
    v_perm_b32 v192, v209, v208, v229
    v_perm_b32 v193, v211, v210, v230
    v_mfma_f32_16x16x32_bf16 v[252:255], a[28:31], v[140:143], v[252:255]
    v_or_b32 v192, v192, v193
    v_xor_b32 v194, s43, v192
    v_perm_b32 v192, v213, v212, v229
    v_perm_b32 v193, v215, v214, v230
    v_or_b32 v192, v192, v193
    v_xor_b32 v195, s43, v192
    v_perm_b32 v192, v217, v216, v229
    v_perm_b32 v193, v219, v218, v230
    v_or_b32 v192, v192, v193
    v_xor_b32 v196, s43, v192
    v_perm_b32 v192, v221, v220, v229
    v_perm_b32 v193, v223, v222, v230
    v_or_b32 v192, v192, v193
    v_xor_b32 v197, s43, v192
    v_or3_b32 v192, v194, v195, v196
    v_or_b32 v192, v192, v197
    v_cmp_ne_u32 vcc, 0, v192
    v_add_f32 v208, v208, v144
    v_add_f32 v209, v209, v145
    v_add_f32 v210, v210, v146
    v_add_f32 v211, v211, v147
    v_add_f32 v212, v212, v148
    v_add_f32 v213, v213, v149
    v_add_f32 v214, v214, v150
    v_add_f32 v215, v215, v151
    v_add_f32 v216, v216, v152
    v_add_f32 v217, v217, v153
    v_add_f32 v218, v218, v154
    v_add_f32 v219, v219, v155
    v_add_f32 v220, v220, v156
    v_add_f32 v221, v221, v157
    v_add_f32 v222, v222, v158
    v_add_f32 v223, v223, v159
    s_mov_b32 s75, 0
    s_nop 2
    s_cbranch_vccz RETRYX_12
RETRY_11:
    buffer_load_dwordx4 v[208:211], v4, s[56:59], s95 offen offset:0 sc1
    buffer_load_dwordx4 v[212:215], v4, s[56:59], s95 offen offset:1024 sc1
    buffer_load_dwordx4 v[216:219], v4, s[56:59], s95 offen offset:2048 sc1
    buffer_load_dwordx4 v[220:223], v4, s[56:59], s95 offen offset:3072 sc1
    s_add_u32 s75, s75, 1
    s_waitcnt vmcnt(0)
    v_perm_b32 v192, v209, v208, v229
    v_perm_b32 v193, v211, v210, v230
    v_or_b32 v192, v192, v193
    v_xor_b32 v194, s43, v192
    v_perm_b32 v192, v213, v212, v229
    v_perm_b32 v193, v215, v214, v230
    v_or_b32 v192, v192, v193
    v_xor_b32 v195, s43, v192
    v_perm_b32 v192, v217, v216, v229
    v_perm_b32 v193, v219, v218, v230
    v_or_b32 v192, v192, v193
    v_xor_b32 v196, s43, v192
    v_perm_b32 v192, v221, v220, v229
    v_perm_b32 v193, v223, v222, v230
    v_or_b32 v192, v192, v193
    v_xor_b32 v197, s43, v192
    v_or3_b32 v192, v194, v195, v196
    v_or_b32 v192, v192, v197
    v_cmp_ne_u32 vcc, 0, v192
    v_pk_add_f32 v[208:209], v[208:209], v[144:145]
    v_pk_add_f32 v[210:211], v[210:211], v[146:147]
    v_pk_add_f32 v[212:213], v[212:213], v[148:149]
    v_pk_add_f32 v[214:215], v[214:215], v[150:151]
    v_pk_add_f32 v[216:217], v[216:217], v[152:153]
    v_pk_add_f32 v[218:219], v[218:219], v[154:155]
    v_pk_add_f32 v[220:221], v[220:221], v[156:157]
    v_pk_add_f32 v[222:223], v[222:223], v[158:159]
    s_cmp_gt_u32 s75, 0x40000
    s_cbranch_scc1 RETRYX_12
    s_cbranch_vccnz RETRY_11
RETRYX_12:
    s_nop 1
    v_pk_add_f32 v[240:241], v[240:241], v[208:209]
    v_pk_add_f32 v[242:243], v[242:243], v[210:211]
    v_pk_add_f32 v[244:245], v[244:245], v[212:213]
    v_pk_add_f32 v[246:247], v[246:247], v[214:215]
    v_pk_add_f32 v[248:249], v[248:249], v[216:217]
    v_pk_add_f32 v[250:251], v[250:251], v[218:219]
    v_pk_add_f32 v[252:253], v[252:253], v[220:221]
    v_pk_add_f32 v[254:255], v[254:255], v[222:223]
    v_cvt_pk_bf16_f32 v192, v240, v241
    v_cvt_pk_bf16_f32 v193, v242, v243
    v_cvt_pk_bf16_f32 v194, v244, v245
    v_cvt_pk_bf16_f32 v195, v246, v247
    v_cvt_pk_bf16_f32 v196, v248, v249
    v_cvt_pk_bf16_f32 v197, v250, v251
    v_cvt_pk_bf16_f32 v198, v252, v253
    v_cvt_pk_bf16_f32 v199, v254, v255
    s_nop 1
    v_permlane16_swap_b32 v192, v194
    v_permlane16_swap_b32 v193, v195
    v_permlane16_swap_b32 v196, v198
    v_permlane16_swap_b32 v197, v199
    buffer_store_dwordx4 v[192:195], v5, s[52:55], s96 offen offset:0 sc1
    buffer_store_dwordx4 v[196:199], v5, s[52:55], s96 offen offset:64 sc1
FINISH:
DONE:
    s_endpgm
.section .rodata,"a"
.p2align 6
.amdhsa_kernel standalone__weight_only_int_quip__sampling_kernel
  .amdhsa_next_free_vgpr 512
  .amdhsa_next_free_sgpr 102
  .amdhsa_accum_offset 256
  .amdhsa_group_segment_fixed_size 0
  .amdhsa_kernarg_size 72
  .amdhsa_user_sgpr_count 2
  .amdhsa_user_sgpr_kernarg_segment_ptr 1
  .amdhsa_system_sgpr_workgroup_id_x 1
.end_amdhsa_kernel
```
